```python
import torch

def _softmax(x, axis=-1):
    return torch.softmax(x, dim=axis)

def _gelu(x):
    return torch.nn.functional.gelu(x, approximate='tanh')

def _silu(x):
    return torch.nn.functional.silu(x)

def _sigmoid(x):
    return torch.sigmoid(x)

def _layernorm(x, axis=-1, eps=1e-05):
    m = x.mean(dim=axis, keepdim=True)
    v = x.var(dim=axis, keepdim=True, unbiased=False)
    return (x - m) / torch.sqrt(v + eps)

def _scatter_add(tgt, idx, src, axis=0):
    return tgt.clone().index_add_(axis, idx, src)

def _segment_sum(src, seg, n):
    out = torch.zeros((n,) + src.shape[1:], dtype=src.dtype)
    return out.index_add_(0, seg, src)

def _pad(x, pw):
    flat = tuple((v for pair in reversed(pw) for v in pair))
    return torch.nn.functional.pad(x, flat)
kernel_name = 'standalone__window_attn_twins__vision'

def setup_inputs():

    _w = lambda a: (lambda t: t.to(torch.bfloat16) if t.is_floating_point() else t)(torch.as_tensor(a))
    H = W = 224 // 7 * 7
    C = 96
    return {'x': _w((lambda *s: torch.randn(*s, dtype=torch.bfloat16) * 0.8)(1, H, W, C)), 'wq': _w((lambda *s: torch.randn(*s, dtype=torch.bfloat16) * 0.8)(C, C)), 'wkv': _w((lambda *s: torch.randn(*s, dtype=torch.bfloat16) * 0.8)(C, 2 * C)), 'wo': _w((lambda *s: torch.randn(*s, dtype=torch.bfloat16) * 0.05)(C, C))}

def reference(x, wq, wkv, wo):
    B, H, W, C = x.shape
    win = 7
    nh, nw = (H // win, W // win)
    xs = x.reshape(B, nh, win, nw, win, C).mean(axis=(2, 4)).reshape(B, nh * nw, C)
    q = x.reshape(B, H * W, C) @ wq
    kv = xs @ wkv
    k, v = (kv[..., :C].clone(), kv[..., C:].clone())
    scale = C ** (-0.5)
    p = _softmax(torch.einsum('bqc,bkc->bqk', q, k) * scale, axis=-1)
    o = torch.einsum('bqk,bkc->bqc', p, v) @ wo
    return o.reshape(B, H, W, C)
```

```asm
; @launch grid=(256,1,1) block=(256,1,1) lds=117568
.amdgcn_target "amdgcn-amd-amdhsa--gfx950"
.text
.globl standalone__window_attn_twins__vision_kernel
.p2align 8
.type standalone__window_attn_twins__vision_kernel,@function
standalone__window_attn_twins__vision_kernel:
    s_cmp_ge_u32 s2, 256
    s_cbranch_scc1 L_done
    s_load_dwordx8 s[4:11], s[0:1], 0
    s_load_dwordx4 s[12:15], s[0:1], 32
    s_load_dwordx2 s[16:17], s[0:1], 48
    s_getpc_b64 s[88:89]
L_pc:
    s_lshr_b32 s47, s2, 3
    s_lshl_b32 s48, s47, 12
    v_lshl_add_u32 v9, v0, 4, s48
    s_mov_b32 s90, L_end-L_pc
    s_mov_b32 s91, 0x00020000
    v_and_b32 v9, 0x7fff, v9
    v_lshrrev_b32 v8, 6, v0
    v_and_b32 v0, 63, v0
    buffer_load_dwordx4 a[252:255], v9, s[88:91], 0 offen
    v_lshlrev_b32 v20, 4, v0
    v_readfirstlane_b32 s44, v8
    v_mov_b32 v18, 1073741824
    s_and_b32 s48, s2, 7
    s_mul_i32 s47, s47, 301056
    s_mul_i32 s48, s48, 5376
    s_add_u32 s47, s47, s48
    s_mov_b32 s35, 0x00020000
    s_cmp_ge_u32 s44, 2
    s_cbranch_scc1 L_wpath
    v_cmp_gt_u32 vcc, 40, v0
    s_mul_i32 s48, s44, 2688
    s_add_u32 s48, s48, s47
    s_mul_i32 s49, s44, 21504
    s_add_u32 s49, s49, 73728
    s_add_u32 s50, s49, 21504
    v_cndmask_b32 v21, v18, v20, vcc
    s_mov_b32 s34, 9633792
    s_waitcnt lgkmcnt(0)
    s_mov_b32 s32, s4
    s_mov_b32 s33, s5
    s_setprio 1
    s_mov_b32 s28, s16
    s_mov_b32 s29, s17
    s_mov_b32 s30, 268435456
    s_mov_b32 s31, 0x00020000
    s_lshl_b32 s59, s2, 2
    s_add_u32 s59, s59, s44
    s_cmp_lg_u32 s59, 1009
    s_cbranch_scc1 L_nz0
    v_lshlrev_b32 v29, 7, v0
    v_mov_b32 v32, 0
    v_mov_b32 v33, 0
    v_mov_b32 v34, 0
    v_mov_b32 v35, 0
    s_mov_b32 s51, 524288
    buffer_store_dwordx4 v[32:35], v29, s[28:31], s51 offen sc1
    s_mov_b32 s51, 532480
    v_lshlrev_b32 v29, 5, v0
    buffer_store_dwordx4 v[32:35], v29, s[28:31], s51 offen sc1
L_nz0:
    s_cmp_lt_u32 s2, 64
    s_cbranch_scc1 L_xdma
    s_barrier
L_xdma:
    s_mov_b32 m0, s49
    s_add_u32 s49, s49, 3072
    buffer_load_dwordx4 v20, s[32:35], s48 offen offset:0 nt lds
    buffer_load_dwordx4 v20, s[32:35], s48 offen offset:1024 nt lds
    buffer_load_dwordx4 v21, s[32:35], s48 offen offset:2048 nt lds
    s_add_u32 s48, s48, 43008
    s_cmp_lt_u32 s49, s50
    s_cbranch_scc1 L_xdma
    s_cmp_ge_u32 s2, 64
    s_cbranch_scc1 L_pool
    s_barrier
    s_branch L_pool
L_wpath:
    s_mov_b32 s92, 0
    s_mov_b32 s93, -1024
    s_mov_b32 s94, -2048
    s_sub_u32 s54, s44, 2
    v_add_u32 v19, 0, v0
    v_mul_u32_u24 v24, 5462, v19
    v_lshlrev_b32 v19, 4, v19
    v_lshrrev_b32 v24, 16, v24
    v_mul_u32_u24 v24, 192, v24
    v_add3_u32 v21, v24, v19, s92
    v_add_u32 v19, 64, v0
    v_mul_u32_u24 v24, 5462, v19
    v_lshlrev_b32 v19, 4, v19
    v_lshrrev_b32 v24, 16, v24
    v_mul_u32_u24 v24, 192, v24
    v_add3_u32 v22, v24, v19, s93
    v_add_u32 v19, 128, v0
    v_mul_u32_u24 v24, 5462, v19
    v_lshlrev_b32 v19, 4, v19
    v_lshrrev_b32 v24, 16, v24
    v_mul_u32_u24 v24, 192, v24
    v_add3_u32 v23, v24, v19, s94
    s_mul_i32 s48, s54, 192
    s_mul_i32 s49, s54, 36864
    s_add_u32 s50, s49, 18432
    s_mov_b32 s34, 36864
    s_waitcnt lgkmcnt(0)
    s_mov_b32 s32, s8
    s_mov_b32 s33, s9
    s_cmp_ge_u32 s2, 64
    s_cbranch_scc1 L_nb1
    s_barrier
L_nb1:
    s_add_u32 s50, s49, 9216
L_w1a:
    s_mov_b32 m0, s49
    s_add_u32 s49, s49, 3072
    buffer_load_dwordx4 v21, s[32:35], s48 offen offset:0  lds
    buffer_load_dwordx4 v22, s[32:35], s48 offen offset:1024  lds
    buffer_load_dwordx4 v23, s[32:35], s48 offen offset:2048  lds
    s_add_u32 s48, s48, 6144
    s_cmp_lt_u32 s49, s50
    s_cbranch_scc1 L_w1a
    s_cmp_lt_u32 s2, 64
    s_cbranch_scc1 L_nb2
    s_barrier
L_nb2:
    s_add_u32 s50, s49, 9216
L_w1b:
    s_mov_b32 m0, s49
    s_add_u32 s49, s49, 3072
    buffer_load_dwordx4 v21, s[32:35], s48 offen offset:0  lds
    buffer_load_dwordx4 v22, s[32:35], s48 offen offset:1024  lds
    buffer_load_dwordx4 v23, s[32:35], s48 offen offset:2048  lds
    s_add_u32 s48, s48, 6144
    s_cmp_lt_u32 s49, s50
    s_cbranch_scc1 L_w1b
    s_cmp_eq_u32 s54, 0
    s_cselect_b32 s36, s6, s10
    s_cselect_b32 s37, s7, s11
    s_mov_b32 s38, 18432
    s_mov_b32 s39, 0x00020000
    s_mov_b32 s48, 0
    s_cmp_ge_u32 s2, 64
    s_cbranch_scc1 L_w2u
    s_add_u32 s50, s49, 18432
L_w2dma:
    s_mov_b32 m0, s49
    s_add_u32 s49, s49, 3072
    buffer_load_dwordx4 v20, s[36:39], s48 offen offset:0  lds
    buffer_load_dwordx4 v20, s[36:39], s48 offen offset:1024  lds
    buffer_load_dwordx4 v20, s[36:39], s48 offen offset:2048  lds
    s_add_u32 s48, s48, 3072
    s_cmp_lt_u32 s49, s50
    s_cbranch_scc1 L_w2dma
    s_branch L_w2e
L_w2u:
    s_mov_b32 m0, s49
    s_add_u32 s49, s49, 3072
    buffer_load_dwordx4 v20, s[36:39], s48 offen offset:0 lds
    v_accvgpr_write_b32 a0, 0
    v_accvgpr_write_b32 a1, 0
    v_accvgpr_write_b32 a2, 0
    v_accvgpr_write_b32 a3, 0
    v_accvgpr_write_b32 a4, 0
    v_accvgpr_write_b32 a5, 0
    v_accvgpr_write_b32 a6, 0
    v_accvgpr_write_b32 a7, 0
    v_accvgpr_write_b32 a8, 0
    v_accvgpr_write_b32 a9, 0
    v_accvgpr_write_b32 a10, 0
    buffer_load_dwordx4 v20, s[36:39], s48 offen offset:1024 lds
    v_accvgpr_write_b32 a11, 0
    v_accvgpr_write_b32 a12, 0
    v_accvgpr_write_b32 a13, 0
    v_accvgpr_write_b32 a14, 0
    v_accvgpr_write_b32 a15, 0
    v_accvgpr_write_b32 a16, 0
    v_accvgpr_write_b32 a17, 0
    v_accvgpr_write_b32 a18, 0
    v_accvgpr_write_b32 a19, 0
    v_accvgpr_write_b32 a20, 0
    v_accvgpr_write_b32 a21, 0
    v_accvgpr_write_b32 a22, 0
    buffer_load_dwordx4 v20, s[36:39], s48 offen offset:2048 lds
    s_add_u32 s48, s48, 3072
    v_accvgpr_write_b32 a23, 0
    v_accvgpr_write_b32 a24, 0
    v_accvgpr_write_b32 a25, 0
    v_accvgpr_write_b32 a26, 0
    v_accvgpr_write_b32 a27, 0
    v_accvgpr_write_b32 a28, 0
    v_accvgpr_write_b32 a29, 0
    v_accvgpr_write_b32 a30, 0
    v_accvgpr_write_b32 a31, 0
    v_accvgpr_write_b32 a32, 0
    v_accvgpr_write_b32 a33, 0
    s_mov_b32 m0, s49
    s_add_u32 s49, s49, 3072
    buffer_load_dwordx4 v20, s[36:39], s48 offen offset:0 lds
    v_accvgpr_write_b32 a34, 0
    v_accvgpr_write_b32 a35, 0
    v_accvgpr_write_b32 a36, 0
    v_accvgpr_write_b32 a37, 0
    v_accvgpr_write_b32 a38, 0
    v_accvgpr_write_b32 a39, 0
    v_accvgpr_write_b32 a40, 0
    v_accvgpr_write_b32 a41, 0
    v_accvgpr_write_b32 a42, 0
    v_accvgpr_write_b32 a43, 0
    v_accvgpr_write_b32 a44, 0
    v_accvgpr_write_b32 a45, 0
    buffer_load_dwordx4 v20, s[36:39], s48 offen offset:1024 lds
    v_accvgpr_write_b32 a46, 0
    v_accvgpr_write_b32 a47, 0
    v_accvgpr_write_b32 a48, 0
    v_accvgpr_write_b32 a49, 0
    v_accvgpr_write_b32 a50, 0
    v_accvgpr_write_b32 a51, 0
    v_accvgpr_write_b32 a52, 0
    v_accvgpr_write_b32 a53, 0
    v_accvgpr_write_b32 a54, 0
    v_accvgpr_write_b32 a55, 0
    v_accvgpr_write_b32 a56, 0
    buffer_load_dwordx4 v20, s[36:39], s48 offen offset:2048 lds
    s_add_u32 s48, s48, 3072
    v_accvgpr_write_b32 a57, 0
    v_accvgpr_write_b32 a58, 0
    v_accvgpr_write_b32 a59, 0
    v_accvgpr_write_b32 a60, 0
    v_accvgpr_write_b32 a61, 0
    v_accvgpr_write_b32 a62, 0
    v_accvgpr_write_b32 a63, 0
    v_accvgpr_write_b32 a64, 0
    v_accvgpr_write_b32 a65, 0
    v_accvgpr_write_b32 a66, 0
    v_accvgpr_write_b32 a67, 0
    v_accvgpr_write_b32 a68, 0
    s_mov_b32 m0, s49
    s_add_u32 s49, s49, 3072
    buffer_load_dwordx4 v20, s[36:39], s48 offen offset:0 lds
    v_accvgpr_write_b32 a69, 0
    v_accvgpr_write_b32 a70, 0
    v_accvgpr_write_b32 a71, 0
    v_accvgpr_write_b32 a72, 0
    v_accvgpr_write_b32 a73, 0
    v_accvgpr_write_b32 a74, 0
    v_accvgpr_write_b32 a75, 0
    v_accvgpr_write_b32 a76, 0
    v_accvgpr_write_b32 a77, 0
    v_accvgpr_write_b32 a78, 0
    v_accvgpr_write_b32 a79, 0
    buffer_load_dwordx4 v20, s[36:39], s48 offen offset:1024 lds
    v_accvgpr_write_b32 a80, 0
    v_accvgpr_write_b32 a81, 0
    v_accvgpr_write_b32 a82, 0
    v_accvgpr_write_b32 a83, 0
    v_accvgpr_write_b32 a84, 0
    v_accvgpr_write_b32 a85, 0
    v_accvgpr_write_b32 a86, 0
    v_accvgpr_write_b32 a87, 0
    v_accvgpr_write_b32 a88, 0
    v_accvgpr_write_b32 a89, 0
    v_accvgpr_write_b32 a90, 0
    v_accvgpr_write_b32 a91, 0
    buffer_load_dwordx4 v20, s[36:39], s48 offen offset:2048 lds
    s_add_u32 s48, s48, 3072
    v_accvgpr_write_b32 a92, 0
    v_accvgpr_write_b32 a93, 0
    v_accvgpr_write_b32 a94, 0
    v_accvgpr_write_b32 a95, 0
    v_accvgpr_write_b32 a228, 0
    v_accvgpr_write_b32 a229, 0
    v_accvgpr_write_b32 a230, 0
    v_accvgpr_write_b32 a231, 0
    v_accvgpr_write_b32 a232, 0
    v_accvgpr_write_b32 a233, 0
    v_accvgpr_write_b32 a234, 0
    s_mov_b32 m0, s49
    s_add_u32 s49, s49, 3072
    buffer_load_dwordx4 v20, s[36:39], s48 offen offset:0 lds
    v_accvgpr_write_b32 a235, 0
    v_accvgpr_write_b32 a236, 0
    v_accvgpr_write_b32 a237, 0
    v_accvgpr_write_b32 a238, 0
    v_accvgpr_write_b32 a239, 0
    v_accvgpr_write_b32 a240, 0
    v_accvgpr_write_b32 a241, 0
    v_accvgpr_write_b32 a242, 0
    v_accvgpr_write_b32 a243, 0
    v_accvgpr_write_b32 a244, 0
    v_accvgpr_write_b32 a245, 0
    v_accvgpr_write_b32 a246, 0
    buffer_load_dwordx4 v20, s[36:39], s48 offen offset:1024 lds
    v_accvgpr_write_b32 a247, 0
    v_accvgpr_write_b32 a248, 0
    v_accvgpr_write_b32 a249, 0
    v_accvgpr_write_b32 a250, 0
    v_accvgpr_write_b32 a251, 0
    v_accvgpr_write_b32 a252, 0
    v_accvgpr_write_b32 a253, 0
    v_accvgpr_write_b32 a254, 0
    v_accvgpr_write_b32 a255, 0
    v_mov_b32 v120, 0
    v_mov_b32 v121, 0
    buffer_load_dwordx4 v20, s[36:39], s48 offen offset:2048 lds
    s_add_u32 s48, s48, 3072
    v_mov_b32 v122, 0
    v_mov_b32 v123, 0
    v_mov_b32 v124, 0
    v_mov_b32 v125, 0
    v_mov_b32 v126, 0
    v_mov_b32 v127, 0
    v_mov_b32 v128, 0
    v_mov_b32 v129, 0
    v_mov_b32 v130, 0
    v_mov_b32 v131, 0
    v_mov_b32 v132, 0
    v_mov_b32 v133, 0
    s_mov_b32 m0, s49
    s_add_u32 s49, s49, 3072
    buffer_load_dwordx4 v20, s[36:39], s48 offen offset:0 lds
    v_mov_b32 v134, 0
    v_mov_b32 v135, 0
    v_mov_b32 v136, 0
    v_mov_b32 v137, 0
    v_mov_b32 v138, 0
    v_mov_b32 v139, 0
    v_mov_b32 v140, 0
    v_mov_b32 v141, 0
    v_mov_b32 v142, 0
    v_mov_b32 v143, 0
    v_mov_b32 v144, 0
    buffer_load_dwordx4 v20, s[36:39], s48 offen offset:1024 lds
    v_mov_b32 v145, 0
    v_mov_b32 v146, 0
    v_mov_b32 v147, 0
    v_mov_b32 v148, 0
    v_mov_b32 v149, 0
    v_mov_b32 v150, 0
    v_mov_b32 v151, 0
    v_mov_b32 v152, 0
    v_mov_b32 v153, 0
    v_mov_b32 v154, 0
    v_mov_b32 v155, 0
    v_mov_b32 v156, 0
    buffer_load_dwordx4 v20, s[36:39], s48 offen offset:2048 lds
    s_add_u32 s48, s48, 3072
    v_mov_b32 v157, 0
    v_mov_b32 v158, 0
    v_mov_b32 v159, 0
    v_mov_b32 v160, 0
    v_mov_b32 v161, 0
    v_mov_b32 v162, 0
    v_mov_b32 v163, 0
    v_mov_b32 v164, 0
    v_mov_b32 v165, 0
    v_mov_b32 v166, 0
    v_mov_b32 v167, 0
    s_mov_b32 m0, s49
    s_add_u32 s49, s49, 3072
    buffer_load_dwordx4 v20, s[36:39], s48 offen offset:0 lds
    v_mov_b32 v168, 0
    v_mov_b32 v169, 0
    v_mov_b32 v170, 0
    v_mov_b32 v171, 0
    v_mov_b32 v172, 0
    v_mov_b32 v173, 0
    v_mov_b32 v174, 0
    v_mov_b32 v175, 0
    v_mov_b32 v176, 0
    v_mov_b32 v177, 0
    v_mov_b32 v178, 0
    v_mov_b32 v179, 0
    buffer_load_dwordx4 v20, s[36:39], s48 offen offset:1024 lds
    v_mov_b32 v180, 0
    v_mov_b32 v181, 0
    v_mov_b32 v182, 0
    v_mov_b32 v183, 0
    v_mov_b32 v184, 0
    v_mov_b32 v185, 0
    v_mov_b32 v186, 0
    v_mov_b32 v187, 0
    v_mov_b32 v188, 0
    v_mov_b32 v189, 0
    v_mov_b32 v190, 0
    v_mov_b32 v191, 0
    buffer_load_dwordx4 v20, s[36:39], s48 offen offset:2048 lds
    s_add_u32 s48, s48, 3072
L_w2e:
    s_and_b32 s95, s2, 3
    s_mul_i32 s3, s95, 5376
    s_sub_u32 s3, s47, s3
    s_lshr_b32 s45, s2, 2
    s_and_b32 s45, s45, 2
    s_xor_b32 s95, s95, s45
    s_and_b32 s45, s44, 1
    s_lshr_b32 s46, s44, 1
    s_mul_i32 s63, s46, 24576
    s_mov_b32 s62, 0
    v_and_b32 v16, 15, v0
    v_lshrrev_b32 v17, 4, v0
    s_mov_b32 s28, s16
    s_mov_b32 s29, s17
    s_mov_b32 s30, 268435456
    s_mov_b32 s31, 0x00020000
    s_mov_b32 s40, s14
    s_mov_b32 s41, s15
    s_mov_b32 s42, 256
    s_mov_b32 s43, 0x00020000
    s_mul_i32 s55, s54, 36864
    v_lshrrev_b32 v22, 2, v16
    v_and_b32 v23, 3, v16
    v_lshl_add_u32 v44, v17, 3, v22
    v_mul_u32_u24 v44, 192, v44
    v_lshl_add_u32 v44, v23, 4, v44
    v_add_u32 v44, s55, v44
    v_lshl_add_u32 v47, v22, 3, v23
    v_mul_u32_u24 v47, 192, v47
    v_lshl_add_u32 v47, v17, 4, v47
    v_mul_u32_u24 v45, 192, v23
    v_lshl_add_u32 v45, v17, 4, v45
    v_add_u32 v45, 116736, v45
    v_cmp_gt_u32 vcc, 4, v16
    v_cmp_gt_u32 s[52:53], 16, v0
    s_cmp_eq_u32 s54, 0
    s_cselect_b64 vcc, vcc, s[52:53]
    s_nop 1
    v_cndmask_b32 v46, v18, v20, vcc
    s_lshr_b32 s56, s2, 3
    s_mul_i32 s56, s56, 12288
    s_bfe_u32 s57, s2, 0x10002
    s_and_b32 s58, s2, 3
    s_waitcnt vmcnt(18)
    ds_read_b64_tr_b16 a[180:181], v44 offset:0
    ds_read_b64_tr_b16 a[182:183], v44 offset:768
    ds_read_b64_tr_b16 a[184:185], v44 offset:6144
    ds_read_b64_tr_b16 a[186:187], v44 offset:6912
    ds_read_b64_tr_b16 a[188:189], v44 offset:12288
    ds_read_b64_tr_b16 a[190:191], v44 offset:13056
    ds_read_b64_tr_b16 a[192:193], v44 offset:8
    ds_read_b64_tr_b16 a[194:195], v44 offset:776
    ds_read_b64_tr_b16 a[196:197], v44 offset:6152
    ds_read_b64_tr_b16 a[198:199], v44 offset:6920
    ds_read_b64_tr_b16 a[200:201], v44 offset:12296
    ds_read_b64_tr_b16 a[202:203], v44 offset:13064
    ds_read_b64_tr_b16 a[204:205], v44 offset:64
    ds_read_b64_tr_b16 a[206:207], v44 offset:832
    ds_read_b64_tr_b16 a[208:209], v44 offset:6208
    ds_read_b64_tr_b16 a[210:211], v44 offset:6976
    ds_read_b64_tr_b16 a[212:213], v44 offset:12352
    ds_read_b64_tr_b16 a[214:215], v44 offset:13120
    ds_read_b64_tr_b16 a[216:217], v44 offset:72
    ds_read_b64_tr_b16 a[218:219], v44 offset:840
    ds_read_b64_tr_b16 a[220:221], v44 offset:6216
    ds_read_b64_tr_b16 a[222:223], v44 offset:6984
    ds_read_b64_tr_b16 a[224:225], v44 offset:12360
    ds_read_b64_tr_b16 a[226:227], v44 offset:13128
    ds_read_b64_tr_b16 a[96:97], v44 offset:128
    ds_read_b64_tr_b16 a[98:99], v44 offset:896
    ds_read_b64_tr_b16 a[100:101], v44 offset:6272
    ds_read_b64_tr_b16 a[102:103], v44 offset:7040
    ds_read_b64_tr_b16 a[104:105], v44 offset:12416
    ds_read_b64_tr_b16 a[106:107], v44 offset:13184
    ds_read_b64_tr_b16 a[108:109], v44 offset:136
    ds_read_b64_tr_b16 a[110:111], v44 offset:904
    ds_read_b64_tr_b16 a[112:113], v44 offset:6280
    ds_read_b64_tr_b16 a[114:115], v44 offset:7048
    ds_read_b64_tr_b16 a[116:117], v44 offset:12424
    ds_read_b64_tr_b16 a[118:119], v44 offset:13192
    s_waitcnt lgkmcnt(0)
    s_cmp_eq_u32 s54, 0
    s_cbranch_scc0 L_vp
    s_barrier
    ds_read_b128 a[120:123], v45 offset:0
    ds_read_b128 a[124:127], v45 offset:64
    ds_read_b128 a[128:131], v45 offset:128
    s_waitcnt vmcnt(0)
    s_waitcnt lgkmcnt(0)
    v_mfma_f32_16x16x32_bf16 v[8:11], a[180:183], a[120:123], 0
    ds_read_b128 v[192:195], v47 offset:18432
    v_mfma_f32_16x16x32_bf16 v[8:11], a[184:187], a[124:127], v[8:11]
    ds_read_b128 v[196:199], v47 offset:18496
    v_mfma_f32_16x16x32_bf16 v[8:11], a[188:191], a[128:131], v[8:11]
    ds_read_b128 v[200:203], v47 offset:18560
    v_mfma_f32_16x16x32_bf16 v[12:15], a[192:195], a[120:123], 0
    ds_read_b128 v[204:207], v47 offset:19200
    v_mfma_f32_16x16x32_bf16 v[12:15], a[196:199], a[124:127], v[12:15]
    ds_read_b128 v[208:211], v47 offset:19264
    v_mfma_f32_16x16x32_bf16 v[12:15], a[200:203], a[128:131], v[12:15]
    ds_read_b128 v[212:215], v47 offset:19328
    v_mfma_f32_16x16x32_bf16 v[16:19], a[204:207], a[120:123], 0
    ds_read_b128 v[216:219], v47 offset:24576
    v_mfma_f32_16x16x32_bf16 v[16:19], a[208:211], a[124:127], v[16:19]
    ds_read_b128 v[220:223], v47 offset:24640
    v_mfma_f32_16x16x32_bf16 v[16:19], a[212:215], a[128:131], v[16:19]
    ds_read_b128 v[224:227], v47 offset:24704
    v_mfma_f32_16x16x32_bf16 v[20:23], a[216:219], a[120:123], 0
    ds_read_b128 v[228:231], v47 offset:25344
    v_mfma_f32_16x16x32_bf16 v[20:23], a[220:223], a[124:127], v[20:23]
    ds_read_b128 v[232:235], v47 offset:25408
    v_mfma_f32_16x16x32_bf16 v[20:23], a[224:227], a[128:131], v[20:23]
    ds_read_b128 v[236:239], v47 offset:25472
    v_mfma_f32_16x16x32_bf16 v[24:27], a[96:99], a[120:123], 0
    ds_read_b128 v[56:59], v47 offset:30720
    v_mfma_f32_16x16x32_bf16 v[24:27], a[100:103], a[124:127], v[24:27]
    ds_read_b128 v[60:63], v47 offset:30784
    v_mfma_f32_16x16x32_bf16 v[24:27], a[104:107], a[128:131], v[24:27]
    ds_read_b128 v[64:67], v47 offset:30848
    v_mfma_f32_16x16x32_bf16 v[28:31], a[108:111], a[120:123], 0
    ds_read_b128 v[68:71], v47 offset:31488
    v_mfma_f32_16x16x32_bf16 v[28:31], a[112:115], a[124:127], v[28:31]
    ds_read_b128 v[72:75], v47 offset:31552
    v_mfma_f32_16x16x32_bf16 v[28:31], a[116:119], a[128:131], v[28:31]
    ds_read_b128 v[76:79], v47 offset:31616
    v_cvt_pk_bf16_f32 v32, v8, v9
    v_cvt_pk_bf16_f32 v33, v10, v11
    v_cvt_pk_bf16_f32 v34, v12, v13
    v_cvt_pk_bf16_f32 v35, v14, v15
    v_cvt_pk_bf16_f32 v36, v16, v17
    v_cvt_pk_bf16_f32 v37, v18, v19
    v_cvt_pk_bf16_f32 v38, v20, v21
    v_cvt_pk_bf16_f32 v39, v22, v23
    s_nop 1
    v_cvt_pk_bf16_f32 v40, v24, v25
    v_cvt_pk_bf16_f32 v41, v26, v27
    v_cvt_pk_bf16_f32 v42, v28, v29
    v_cvt_pk_bf16_f32 v43, v30, v31
    s_waitcnt lgkmcnt(0)
    v_mov_b32 v47, 0
    buffer_load_dword v45, v47, s[40:43], 0 offen sc1
    v_mfma_f32_16x16x32_bf16 v[8:11], v[192:195], v[32:35], 0
    v_mfma_f32_16x16x32_bf16 v[8:11], v[196:199], v[36:39], v[8:11]
    v_mfma_f32_16x16x32_bf16 v[8:11], v[200:203], v[40:43], v[8:11]
    v_mfma_f32_16x16x32_bf16 v[12:15], v[204:207], v[32:35], 0
    v_mfma_f32_16x16x32_bf16 v[12:15], v[208:211], v[36:39], v[12:15]
    v_mfma_f32_16x16x32_bf16 v[12:15], v[212:215], v[40:43], v[12:15]
    v_mfma_f32_16x16x32_bf16 v[16:19], v[216:219], v[32:35], 0
    v_mfma_f32_16x16x32_bf16 v[16:19], v[220:223], v[36:39], v[16:19]
    v_mfma_f32_16x16x32_bf16 v[16:19], v[224:227], v[40:43], v[16:19]
    v_mfma_f32_16x16x32_bf16 v[20:23], v[228:231], v[32:35], 0
    v_mfma_f32_16x16x32_bf16 v[20:23], v[232:235], v[36:39], v[20:23]
    v_mfma_f32_16x16x32_bf16 v[20:23], v[236:239], v[40:43], v[20:23]
    v_mfma_f32_16x16x32_bf16 v[24:27], v[56:59], v[32:35], 0
    v_mfma_f32_16x16x32_bf16 v[24:27], v[60:63], v[36:39], v[24:27]
    v_mfma_f32_16x16x32_bf16 v[24:27], v[64:67], v[40:43], v[24:27]
    v_mfma_f32_16x16x32_bf16 v[28:31], v[68:71], v[32:35], 0
    v_mfma_f32_16x16x32_bf16 v[28:31], v[72:75], v[36:39], v[28:31]
    v_mfma_f32_16x16x32_bf16 v[28:31], v[76:79], v[40:43], v[28:31]
    s_mov_b32 s50, 0x3e16c740
    s_mov_b32 s51, 0x3e16c740
    s_mul_i32 s57, s57, 3072
    s_add_u32 s56, s56, s57
    s_lshl_b32 s58, s58, 6
    s_add_u32 s56, s56, s58
    v_pk_mul_f32 v[8:9], v[8:9], s[50:51]
    v_pk_mul_f32 v[10:11], v[10:11], s[50:51]
    v_pk_mul_f32 v[12:13], v[12:13], s[50:51]
    v_pk_mul_f32 v[14:15], v[14:15], s[50:51]
    v_cvt_pk_bf16_f32 v32, v8, v9
    v_cvt_pk_bf16_f32 v33, v10, v11
    v_cvt_pk_bf16_f32 v34, v12, v13
    v_cvt_pk_bf16_f32 v35, v14, v15
    buffer_store_dwordx4 v[32:35], v46, s[28:31], s56 offen offset:0 sc1
    v_pk_mul_f32 v[16:17], v[16:17], s[50:51]
    v_pk_mul_f32 v[18:19], v[18:19], s[50:51]
    v_pk_mul_f32 v[20:21], v[20:21], s[50:51]
    v_pk_mul_f32 v[22:23], v[22:23], s[50:51]
    v_cvt_pk_bf16_f32 v36, v16, v17
    v_cvt_pk_bf16_f32 v37, v18, v19
    v_cvt_pk_bf16_f32 v38, v20, v21
    v_cvt_pk_bf16_f32 v39, v22, v23
    buffer_store_dwordx4 v[36:39], v46, s[28:31], s56 offen offset:1024 sc1
    s_nop 1
    v_pk_mul_f32 v[24:25], v[24:25], s[50:51]
    v_pk_mul_f32 v[26:27], v[26:27], s[50:51]
    v_pk_mul_f32 v[28:29], v[28:29], s[50:51]
    v_pk_mul_f32 v[30:31], v[30:31], s[50:51]
    v_cvt_pk_bf16_f32 v40, v24, v25
    v_cvt_pk_bf16_f32 v41, v26, v27
    v_cvt_pk_bf16_f32 v42, v28, v29
    v_cvt_pk_bf16_f32 v43, v30, v31
    buffer_store_dwordx4 v[40:43], v46, s[28:31], s56 offen offset:2048 sc1
    s_mov_b32 s94, 1
    s_branch L_pj
L_vp:
    s_barrier
    ds_read_b128 a[120:123], v45 offset:0
    ds_read_b128 a[124:127], v45 offset:64
    ds_read_b128 a[128:131], v45 offset:128
    s_waitcnt vmcnt(0)
    s_waitcnt lgkmcnt(0)
    v_mfma_f32_16x16x32_bf16 v[8:11], a[180:183], a[120:123], 0
    ds_read_b64_tr_b16 v[192:193], v44 offset:18432
    ds_read_b64_tr_b16 v[194:195], v44 offset:19200
    v_mfma_f32_16x16x32_bf16 v[8:11], a[184:187], a[124:127], v[8:11]
    ds_read_b64_tr_b16 v[196:197], v44 offset:24576
    ds_read_b64_tr_b16 v[198:199], v44 offset:25344
    v_mfma_f32_16x16x32_bf16 v[8:11], a[188:191], a[128:131], v[8:11]
    ds_read_b64_tr_b16 v[200:201], v44 offset:30720
    ds_read_b64_tr_b16 v[202:203], v44 offset:31488
    v_mfma_f32_16x16x32_bf16 v[12:15], a[192:195], a[120:123], 0
    ds_read_b64_tr_b16 v[204:205], v44 offset:18440
    ds_read_b64_tr_b16 v[206:207], v44 offset:19208
    v_mfma_f32_16x16x32_bf16 v[12:15], a[196:199], a[124:127], v[12:15]
    ds_read_b64_tr_b16 v[208:209], v44 offset:24584
    ds_read_b64_tr_b16 v[210:211], v44 offset:25352
    v_mfma_f32_16x16x32_bf16 v[12:15], a[200:203], a[128:131], v[12:15]
    ds_read_b64_tr_b16 v[212:213], v44 offset:30728
    ds_read_b64_tr_b16 v[214:215], v44 offset:31496
    v_mfma_f32_16x16x32_bf16 v[16:19], a[204:207], a[120:123], 0
    ds_read_b64_tr_b16 v[216:217], v44 offset:18496
    ds_read_b64_tr_b16 v[218:219], v44 offset:19264
    v_mfma_f32_16x16x32_bf16 v[16:19], a[208:211], a[124:127], v[16:19]
    ds_read_b64_tr_b16 v[220:221], v44 offset:24640
    ds_read_b64_tr_b16 v[222:223], v44 offset:25408
    v_mfma_f32_16x16x32_bf16 v[16:19], a[212:215], a[128:131], v[16:19]
    ds_read_b64_tr_b16 v[224:225], v44 offset:30784
    ds_read_b64_tr_b16 v[226:227], v44 offset:31552
    v_mfma_f32_16x16x32_bf16 v[20:23], a[216:219], a[120:123], 0
    ds_read_b64_tr_b16 v[228:229], v44 offset:18504
    ds_read_b64_tr_b16 v[230:231], v44 offset:19272
    v_mfma_f32_16x16x32_bf16 v[20:23], a[220:223], a[124:127], v[20:23]
    ds_read_b64_tr_b16 v[232:233], v44 offset:24648
    ds_read_b64_tr_b16 v[234:235], v44 offset:25416
    v_mfma_f32_16x16x32_bf16 v[20:23], a[224:227], a[128:131], v[20:23]
    ds_read_b64_tr_b16 v[236:237], v44 offset:30792
    ds_read_b64_tr_b16 v[238:239], v44 offset:31560
    v_mfma_f32_16x16x32_bf16 v[24:27], a[96:99], a[120:123], 0
    ds_read_b64_tr_b16 v[56:57], v44 offset:18560
    ds_read_b64_tr_b16 v[58:59], v44 offset:19328
    v_mfma_f32_16x16x32_bf16 v[24:27], a[100:103], a[124:127], v[24:27]
    ds_read_b64_tr_b16 v[60:61], v44 offset:24704
    ds_read_b64_tr_b16 v[62:63], v44 offset:25472
    v_mfma_f32_16x16x32_bf16 v[24:27], a[104:107], a[128:131], v[24:27]
    ds_read_b64_tr_b16 v[64:65], v44 offset:30848
    ds_read_b64_tr_b16 v[66:67], v44 offset:31616
    v_mfma_f32_16x16x32_bf16 v[28:31], a[108:111], a[120:123], 0
    ds_read_b64_tr_b16 v[68:69], v44 offset:18568
    ds_read_b64_tr_b16 v[70:71], v44 offset:19336
    v_mfma_f32_16x16x32_bf16 v[28:31], a[112:115], a[124:127], v[28:31]
    ds_read_b64_tr_b16 v[72:73], v44 offset:24712
    ds_read_b64_tr_b16 v[74:75], v44 offset:25480
    v_mfma_f32_16x16x32_bf16 v[28:31], a[116:119], a[128:131], v[28:31]
    ds_read_b64_tr_b16 v[76:77], v44 offset:30856
    ds_read_b64_tr_b16 v[78:79], v44 offset:31624
    v_cvt_pk_bf16_f32 v32, v8, v9
    v_cvt_pk_bf16_f32 v33, v10, v11
    v_cvt_pk_bf16_f32 v34, v12, v13
    v_cvt_pk_bf16_f32 v35, v14, v15
    v_cvt_pk_bf16_f32 v36, v16, v17
    v_cvt_pk_bf16_f32 v37, v18, v19
    v_cvt_pk_bf16_f32 v38, v20, v21
    v_cvt_pk_bf16_f32 v39, v22, v23
    s_nop 1
    v_cvt_pk_bf16_f32 v40, v24, v25
    v_cvt_pk_bf16_f32 v41, v26, v27
    v_cvt_pk_bf16_f32 v42, v28, v29
    v_cvt_pk_bf16_f32 v43, v30, v31
    s_waitcnt lgkmcnt(0)
    v_mov_b32 v47, 0
    buffer_load_dword v45, v47, s[40:43], 0 offen sc1
    v_mfma_f32_16x16x32_bf16 v[8:11], v[32:35], v[192:195], 0
    v_mfma_f32_16x16x32_bf16 v[8:11], v[36:39], v[196:199], v[8:11]
    v_mfma_f32_16x16x32_bf16 v[8:11], v[40:43], v[200:203], v[8:11]
    v_mfma_f32_16x16x32_bf16 v[12:15], v[32:35], v[204:207], 0
    v_mfma_f32_16x16x32_bf16 v[12:15], v[36:39], v[208:211], v[12:15]
    v_mfma_f32_16x16x32_bf16 v[12:15], v[40:43], v[212:215], v[12:15]
    v_mfma_f32_16x16x32_bf16 v[16:19], v[32:35], v[216:219], 0
    v_mfma_f32_16x16x32_bf16 v[16:19], v[36:39], v[220:223], v[16:19]
    v_mfma_f32_16x16x32_bf16 v[16:19], v[40:43], v[224:227], v[16:19]
    v_mfma_f32_16x16x32_bf16 v[20:23], v[32:35], v[228:231], 0
    v_mfma_f32_16x16x32_bf16 v[20:23], v[36:39], v[232:235], v[20:23]
    v_mfma_f32_16x16x32_bf16 v[20:23], v[40:43], v[236:239], v[20:23]
    v_mfma_f32_16x16x32_bf16 v[24:27], v[32:35], v[56:59], 0
    v_mfma_f32_16x16x32_bf16 v[24:27], v[36:39], v[60:63], v[24:27]
    v_mfma_f32_16x16x32_bf16 v[24:27], v[40:43], v[64:67], v[24:27]
    v_mfma_f32_16x16x32_bf16 v[28:31], v[32:35], v[68:71], 0
    v_mfma_f32_16x16x32_bf16 v[28:31], v[36:39], v[72:75], v[28:31]
    v_mfma_f32_16x16x32_bf16 v[28:31], v[40:43], v[76:79], v[28:31]
    s_lshl_b32 s57, s57, 3
    s_add_u32 s56, s56, s57
    s_lshl_b32 s58, s58, 8
    s_add_u32 s56, s56, s58
    s_add_u32 s56, s56, 6144
    s_add_u32 s57, s56, 4096
    v_cvt_pk_bf16_f32 v8, v8, v9
    v_cvt_pk_bf16_f32 v9, v10, v11
    buffer_store_dwordx2 v[8:9], v46, s[28:31], s56 offen offset:0 sc1
    v_cvt_pk_bf16_f32 v12, v12, v13
    v_cvt_pk_bf16_f32 v13, v14, v15
    buffer_store_dwordx2 v[12:13], v46, s[28:31], s56 offen offset:1024 sc1
    v_cvt_pk_bf16_f32 v16, v16, v17
    v_cvt_pk_bf16_f32 v17, v18, v19
    buffer_store_dwordx2 v[16:17], v46, s[28:31], s56 offen offset:2048 sc1
    v_cvt_pk_bf16_f32 v20, v20, v21
    v_cvt_pk_bf16_f32 v21, v22, v23
    buffer_store_dwordx2 v[20:21], v46, s[28:31], s56 offen offset:3072 sc1
    v_cvt_pk_bf16_f32 v24, v24, v25
    v_cvt_pk_bf16_f32 v25, v26, v27
    buffer_store_dwordx2 v[24:25], v46, s[28:31], s57 offen offset:0 sc1
    v_cvt_pk_bf16_f32 v28, v28, v29
    v_cvt_pk_bf16_f32 v29, v30, v31
    buffer_store_dwordx2 v[28:29], v46, s[28:31], s57 offen offset:1024 sc1
    s_mov_b32 s50, 0x7fff7fff
    v_and_b32 v32, s50, v8
    v_and_b32 v33, s50, v9
    v_and_b32 v34, s50, v12
    v_and_b32 v35, s50, v13
    v_and_b32 v36, s50, v16
    v_and_b32 v37, s50, v17
    v_and_b32 v38, s50, v20
    v_and_b32 v39, s50, v21
    v_and_b32 v40, s50, v24
    v_and_b32 v41, s50, v25
    v_and_b32 v42, s50, v28
    v_and_b32 v43, s50, v29
    v_pk_max_u16 v32, v32, v38
    v_pk_max_u16 v33, v33, v39
    v_pk_max_u16 v34, v34, v40
    v_pk_max_u16 v35, v35, v41
    v_pk_max_u16 v36, v36, v42
    v_pk_max_u16 v37, v37, v43
    v_pk_max_u16 v32, v32, v35
    v_pk_max_u16 v33, v33, v36
    v_pk_max_u16 v34, v34, v37
    v_pk_max_u16 v32, v32, v33
    v_pk_max_u16 v32, v32, v34
    v_lshrrev_b32 v33, 16, v32
    v_and_b32 v32, 0xffff, v32
    v_max_u32 v32, v32, v33
    v_cmp_lt_u32 vcc, 20096, v32
    s_mov_b32 s94, 1
    s_cmp_lg_u64 vcc, 0
    s_cselect_b32 s94, 0x10001, s94
L_pj:
    s_mov_b32 s24, s12
    s_mov_b32 s25, s13
    s_mov_b32 s26, 9633792
    s_mov_b32 s27, 0x00020000
    v_and_b32 v8, 15, v0
    v_lshrrev_b32 v9, 4, v0
    v_lshlrev_b32 v9, 4, v9
    v_lshlrev_b32 v90, 7, v8
    v_add_u32 v90, 528384, v90
    v_lshlrev_b32 v3, 4, v0
    v_add_u32 v4, 4096, v3
    v_add_u32 v5, 8192, v3
    s_mul_i32 s48, s44, 28672
    v_add_u32 v6, s48, v3
    s_xor_b32 s48, s44, 2
    s_mul_i32 s48, s48, 28672
    v_add_u32 v7, s48, v3
    s_mul_i32 s48, s45, 96
    s_mul_i32 s49, s46, 48
    s_add_u32 s50, s48, s49
    s_sub_u32 s49, 48, s49
    s_add_u32 s49, s48, s49
    s_mov_b32 s51, 37632
    s_mov_b32 s52, -2304
    s_mov_b32 s53, 18816
    v_add_u32 v13, 73728, v9
    s_add_u32 s48, s49, 0
    v_add_u32 v10, s48, v8
    v_mul_u32_u24 v11, 4682, v10
    v_mul_u32_u24 v10, 192, v10
    v_lshrrev_b32 v12, 17, v11
    v_bfe_u32 v11, v11, 16, 1
    v_mad_i32_i24 v10, v12, s52, v10
    v_mad_u32_u24 v10, v11, s53, v10
    v_add_u32 v92, v10, v13
    s_add_u32 s48, s49, 16
    v_add_u32 v10, s48, v8
    v_mul_u32_u24 v11, 4682, v10
    v_mul_u32_u24 v10, 192, v10
    v_lshrrev_b32 v12, 17, v11
    v_bfe_u32 v11, v11, 16, 1
    v_mad_i32_i24 v10, v12, s52, v10
    v_mad_u32_u24 v10, v11, s53, v10
    v_add_u32 v93, v10, v13
    s_add_u32 s48, s49, 32
    v_add_u32 v10, s48, v8
    v_mul_u32_u24 v11, 4682, v10
    v_mul_u32_u24 v10, 192, v10
    v_lshrrev_b32 v12, 17, v11
    v_bfe_u32 v11, v11, 16, 1
    v_mad_i32_i24 v10, v12, s52, v10
    v_mad_u32_u24 v10, v11, s53, v10
    v_add_u32 v94, v10, v13
    s_add_u32 s48, s50, 0
    v_add_u32 v10, s48, v8
    v_mul_u32_u24 v11, 4682, v10
    v_mul_u32_u24 v10, 192, v10
    v_lshrrev_b32 v12, 17, v11
    v_bfe_u32 v11, v11, 16, 1
    v_mad_u32_u24 v14, v12, s51, v10
    v_add_u32 v240, v14, v9
    v_mad_i32_i24 v10, v12, s52, v10
    v_mad_u32_u24 v10, v11, s53, v10
    v_add_u32 v95, v10, v13
    s_add_u32 s48, s50, 16
    v_add_u32 v10, s48, v8
    v_mul_u32_u24 v11, 4682, v10
    v_mul_u32_u24 v10, 192, v10
    v_lshrrev_b32 v12, 17, v11
    v_bfe_u32 v11, v11, 16, 1
    v_mad_u32_u24 v14, v12, s51, v10
    v_add_u32 v241, v14, v9
    v_mad_i32_i24 v10, v12, s52, v10
    v_mad_u32_u24 v10, v11, s53, v10
    v_add_u32 v96, v10, v13
    s_add_u32 s48, s50, 32
    v_add_u32 v10, s48, v8
    v_mul_u32_u24 v11, 4682, v10
    v_mul_u32_u24 v10, 192, v10
    v_lshrrev_b32 v12, 17, v11
    v_bfe_u32 v11, v11, 16, 1
    v_mad_u32_u24 v14, v12, s51, v10
    v_add_u32 v242, v14, v9
    v_mad_i32_i24 v10, v12, s52, v10
    v_mad_u32_u24 v10, v11, s53, v10
    v_add_u32 v97, v10, v13
    v_lshrrev_b32 v10, 2, v8
    v_and_b32 v11, 3, v8
    v_mul_u32_u24 v10, 5376, v10
    v_mul_u32_u24 v11, 192, v11
    v_add3_u32 v10, v10, v11, v9
    v_add_u32 v243, 262656, v10
    s_min_u32 s48, s44, 2
    s_lshl_b32 s48, s48, 11
    v_add_u32 v1, s48, v3
    ds_read_b128 a[96:99], v92 offset:0
    ds_read_b128 a[100:103], v92 offset:64
    ds_read_b128 a[104:107], v92 offset:128
    ds_read_b128 a[108:111], v93 offset:0
    ds_read_b128 a[112:115], v93 offset:64
    ds_read_b128 a[116:119], v93 offset:128
    ds_read_b128 a[120:123], v94 offset:0
    ds_read_b128 a[124:127], v94 offset:64
    ds_read_b128 a[128:131], v94 offset:128
    ds_read_b128 a[132:135], v95 offset:0
    ds_read_b128 a[136:139], v95 offset:64
    ds_read_b128 a[140:143], v95 offset:128
    ds_read_b128 a[144:147], v96 offset:0
    ds_read_b128 a[148:151], v96 offset:64
    ds_read_b128 a[152:155], v96 offset:128
    ds_read_b128 a[156:159], v97 offset:0
    ds_read_b128 a[160:163], v97 offset:64
    ds_read_b128 a[164:167], v97 offset:128
    s_lshr_b32 s48, s2, 4
    s_lshl_b32 s48, s48, 7
    s_add_u32 s48, s48, 524288
    v_mov_b32 v44, 1
    s_mov_b32 s49, 0x200000
    s_lshl_b32 s57, s2, 3
    s_add_u32 s57, s57, s54
    s_lshl_b32 s57, s57, 2
    s_add_u32 s57, s57, 532480
    s_mov_b64 exec, 1
    s_waitcnt vmcnt(0)
L_wr:
    v_cmp_ne_u32 vcc, 0, v45
    s_sub_u32 s49, s49, 1
    s_cbranch_scc1 L_arr
    s_cbranch_vccnz L_arr
    buffer_load_dword v45, v47, s[40:43], 0 offen sc1
    s_waitcnt vmcnt(0)
    s_branch L_wr
L_arr:
    s_cmp_ge_u32 s2, 64
    s_cbranch_scc1 L_nd
    buffer_store_dword v44, v47, s[28:31], s57 offen sc1
L_nd:
    v_mov_b32 v43, s94
    buffer_atomic_add v43, v47, s[28:31], s48 offen sc0 sc1
    s_mov_b64 exec, -1
    s_add_u32 s58, s48, 4096
    v_and_b32 v10, 63, v0
    v_lshlrev_b32 v10, 5, v10
    v_add_u32 v10, 532480, v10
    v_mov_b32 v12, 1
    v_mov_b32 v13, 1
    v_mov_b32 v12, s54
    s_mov_b32 s20, s4
    s_mov_b32 s21, s5
    s_mov_b32 s22, 9633792
    s_mov_b32 s23, 0x00020000
    buffer_load_dwordx4 a[168:171], v243, s[20:23], s3 offen offset:0
    buffer_load_dwordx4 a[172:175], v243, s[20:23], s3 offen offset:64
    buffer_load_dwordx4 a[176:179], v243, s[20:23], s3 offen offset:128
    v_mov_b32 v92, 0
    v_mov_b32 v93, 0
    v_mov_b32 v94, 0
    v_mov_b32 v95, 0
    v_mov_b32 v96, 0
    v_mov_b32 v97, 0
    v_mov_b32 v98, 0
    v_mov_b32 v99, 0
    v_mov_b32 v100, 0
    v_mov_b32 v101, 0
    v_mov_b32 v102, 0
    v_mov_b32 v103, 0
    v_mov_b32 v104, 0
    v_mov_b32 v105, 0
    v_mov_b32 v106, 0
    v_mov_b32 v107, 0
    v_mov_b32 v108, 0
    v_mov_b32 v109, 0
    v_mov_b32 v110, 0
    v_mov_b32 v111, 0
    v_mov_b32 v112, 0
    v_mov_b32 v113, 0
    v_mov_b32 v114, 0
    v_mov_b32 v115, 0
    v_mov_b32 v116, 0
    v_mov_b32 v117, 0
    v_mov_b32 v118, 0
    v_mov_b32 v119, 0
    v_accvgpr_write_b32 a252, 0
    v_accvgpr_write_b32 a253, 0
    v_accvgpr_write_b32 a254, 0
    v_accvgpr_write_b32 a255, 0
    s_cmp_ge_u32 s2, 64
    s_cbranch_scc1 L_ni
    v_accvgpr_write_b32 a0, 0
    v_accvgpr_write_b32 a1, 0
    v_accvgpr_write_b32 a2, 0
    v_accvgpr_write_b32 a3, 0
    v_accvgpr_write_b32 a4, 0
    v_accvgpr_write_b32 a5, 0
    v_accvgpr_write_b32 a6, 0
    v_accvgpr_write_b32 a7, 0
    v_accvgpr_write_b32 a8, 0
    v_accvgpr_write_b32 a9, 0
    v_accvgpr_write_b32 a10, 0
    v_accvgpr_write_b32 a11, 0
    v_accvgpr_write_b32 a12, 0
    v_accvgpr_write_b32 a13, 0
    v_accvgpr_write_b32 a14, 0
    v_accvgpr_write_b32 a15, 0
    v_accvgpr_write_b32 a16, 0
    v_accvgpr_write_b32 a17, 0
    v_accvgpr_write_b32 a18, 0
    v_accvgpr_write_b32 a19, 0
    v_accvgpr_write_b32 a20, 0
    v_accvgpr_write_b32 a21, 0
    v_accvgpr_write_b32 a22, 0
    v_accvgpr_write_b32 a23, 0
    v_accvgpr_write_b32 a24, 0
    v_accvgpr_write_b32 a25, 0
    v_accvgpr_write_b32 a26, 0
    v_accvgpr_write_b32 a27, 0
    v_accvgpr_write_b32 a28, 0
    v_accvgpr_write_b32 a29, 0
    v_accvgpr_write_b32 a30, 0
    v_accvgpr_write_b32 a31, 0
    v_accvgpr_write_b32 a32, 0
    v_accvgpr_write_b32 a33, 0
    v_accvgpr_write_b32 a34, 0
    v_accvgpr_write_b32 a35, 0
    v_accvgpr_write_b32 a36, 0
    v_accvgpr_write_b32 a37, 0
    v_accvgpr_write_b32 a38, 0
    v_accvgpr_write_b32 a39, 0
    v_accvgpr_write_b32 a40, 0
    v_accvgpr_write_b32 a41, 0
    v_accvgpr_write_b32 a42, 0
    v_accvgpr_write_b32 a43, 0
    v_accvgpr_write_b32 a44, 0
    v_accvgpr_write_b32 a45, 0
    v_accvgpr_write_b32 a46, 0
    v_accvgpr_write_b32 a47, 0
    v_accvgpr_write_b32 a48, 0
    v_accvgpr_write_b32 a49, 0
    v_accvgpr_write_b32 a50, 0
    v_accvgpr_write_b32 a51, 0
    v_accvgpr_write_b32 a52, 0
    v_accvgpr_write_b32 a53, 0
    v_accvgpr_write_b32 a54, 0
    v_accvgpr_write_b32 a55, 0
    v_accvgpr_write_b32 a56, 0
    v_accvgpr_write_b32 a57, 0
    v_accvgpr_write_b32 a58, 0
    v_accvgpr_write_b32 a59, 0
    v_accvgpr_write_b32 a60, 0
    v_accvgpr_write_b32 a61, 0
    v_accvgpr_write_b32 a62, 0
    v_accvgpr_write_b32 a63, 0
    v_accvgpr_write_b32 a64, 0
    v_accvgpr_write_b32 a65, 0
    v_accvgpr_write_b32 a66, 0
    v_accvgpr_write_b32 a67, 0
    v_accvgpr_write_b32 a68, 0
    v_accvgpr_write_b32 a69, 0
    v_accvgpr_write_b32 a70, 0
    v_accvgpr_write_b32 a71, 0
    v_accvgpr_write_b32 a72, 0
    v_accvgpr_write_b32 a73, 0
    v_accvgpr_write_b32 a74, 0
    v_accvgpr_write_b32 a75, 0
    v_accvgpr_write_b32 a76, 0
    v_accvgpr_write_b32 a77, 0
    v_accvgpr_write_b32 a78, 0
    v_accvgpr_write_b32 a79, 0
    v_accvgpr_write_b32 a80, 0
    v_accvgpr_write_b32 a81, 0
    v_accvgpr_write_b32 a82, 0
    v_accvgpr_write_b32 a83, 0
    v_accvgpr_write_b32 a84, 0
    v_accvgpr_write_b32 a85, 0
    v_accvgpr_write_b32 a86, 0
    v_accvgpr_write_b32 a87, 0
    v_accvgpr_write_b32 a88, 0
    v_accvgpr_write_b32 a89, 0
    v_accvgpr_write_b32 a90, 0
    v_accvgpr_write_b32 a91, 0
    v_accvgpr_write_b32 a92, 0
    v_accvgpr_write_b32 a93, 0
    v_accvgpr_write_b32 a94, 0
    v_accvgpr_write_b32 a95, 0
    v_accvgpr_write_b32 a228, 0
    v_accvgpr_write_b32 a229, 0
    v_accvgpr_write_b32 a230, 0
    v_accvgpr_write_b32 a231, 0
    v_accvgpr_write_b32 a232, 0
    v_accvgpr_write_b32 a233, 0
    v_accvgpr_write_b32 a234, 0
    v_accvgpr_write_b32 a235, 0
    v_accvgpr_write_b32 a236, 0
    v_accvgpr_write_b32 a237, 0
    v_accvgpr_write_b32 a238, 0
    v_accvgpr_write_b32 a239, 0
    v_accvgpr_write_b32 a240, 0
    v_accvgpr_write_b32 a241, 0
    v_accvgpr_write_b32 a242, 0
    v_accvgpr_write_b32 a243, 0
    v_accvgpr_write_b32 a244, 0
    v_accvgpr_write_b32 a245, 0
    v_accvgpr_write_b32 a246, 0
    v_accvgpr_write_b32 a247, 0
    v_accvgpr_write_b32 a248, 0
    v_accvgpr_write_b32 a249, 0
    v_accvgpr_write_b32 a250, 0
    v_accvgpr_write_b32 a251, 0
    v_accvgpr_write_b32 a252, 0
    v_accvgpr_write_b32 a253, 0
    v_accvgpr_write_b32 a254, 0
    v_accvgpr_write_b32 a255, 0
    v_mov_b32 v120, 0
    v_mov_b32 v121, 0
    v_mov_b32 v122, 0
    v_mov_b32 v123, 0
    v_mov_b32 v124, 0
    v_mov_b32 v125, 0
    v_mov_b32 v126, 0
    v_mov_b32 v127, 0
    v_mov_b32 v128, 0
    v_mov_b32 v129, 0
    v_mov_b32 v130, 0
    v_mov_b32 v131, 0
    v_mov_b32 v132, 0
    v_mov_b32 v133, 0
    v_mov_b32 v134, 0
    v_mov_b32 v135, 0
    v_mov_b32 v136, 0
    v_mov_b32 v137, 0
    v_mov_b32 v138, 0
    v_mov_b32 v139, 0
    v_mov_b32 v140, 0
    v_mov_b32 v141, 0
    v_mov_b32 v142, 0
    v_mov_b32 v143, 0
    v_mov_b32 v144, 0
    v_mov_b32 v145, 0
    v_mov_b32 v146, 0
    v_mov_b32 v147, 0
    v_mov_b32 v148, 0
    v_mov_b32 v149, 0
    v_mov_b32 v150, 0
    v_mov_b32 v151, 0
    v_mov_b32 v152, 0
    v_mov_b32 v153, 0
    v_mov_b32 v154, 0
    v_mov_b32 v155, 0
    v_mov_b32 v156, 0
    v_mov_b32 v157, 0
    v_mov_b32 v158, 0
    v_mov_b32 v159, 0
    v_mov_b32 v160, 0
    v_mov_b32 v161, 0
    v_mov_b32 v162, 0
    v_mov_b32 v163, 0
    v_mov_b32 v164, 0
    v_mov_b32 v165, 0
    v_mov_b32 v166, 0
    v_mov_b32 v167, 0
    v_mov_b32 v168, 0
    v_mov_b32 v169, 0
    v_mov_b32 v170, 0
    v_mov_b32 v171, 0
    v_mov_b32 v172, 0
    v_mov_b32 v173, 0
    v_mov_b32 v174, 0
    v_mov_b32 v175, 0
    v_mov_b32 v176, 0
    v_mov_b32 v177, 0
    v_mov_b32 v178, 0
    v_mov_b32 v179, 0
    v_mov_b32 v180, 0
    v_mov_b32 v181, 0
    v_mov_b32 v182, 0
    v_mov_b32 v183, 0
    v_mov_b32 v184, 0
    v_mov_b32 v185, 0
    v_mov_b32 v186, 0
    v_mov_b32 v187, 0
    v_mov_b32 v188, 0
    v_mov_b32 v189, 0
    v_mov_b32 v190, 0
    v_mov_b32 v191, 0
L_ni:
    s_mov_b64 exec, 1
    s_waitcnt vmcnt(3)
    v_add_u32 v43, s94, v43
    v_and_b32 v44, 0xffff, v43
    v_lshrrev_b32 v45, 16, v43
    v_cmp_eq_u32 vcc, 32, v44
    v_add_u32 v45, 1, v45
    s_and_b64 exec, exec, vcc
    s_cbranch_execz L_nl
    buffer_store_dword v45, v47, s[28:31], s58 offen sc1
L_nl:
    s_mov_b64 exec, -1
    s_cmp_eq_u32 s54, 0
    s_cbranch_scc1 L_nw
    s_lshr_b32 s50, s2, 3
    s_mul_i32 s50, s50, 1536
    buffer_load_dwordx4 v[16:19], v3, s[28:31], s50 offen sc1
    buffer_load_dwordx4 v[20:23], v3, s[28:31], s50 offen offset:512 sc1
L_nw:
    s_mov_b32 s49, 0x200000
    s_cmp_eq_u32 s54, 0
    s_cbranch_scc1 L_poll1
    s_branch L_go
L_pool:
    s_setprio 0
    s_mov_b32 s40, s14
    s_mov_b32 s41, s15
    s_mov_b32 s42, 256
    s_mov_b32 s43, 0x00020000
    s_cmp_lg_u32 s59, 1009
    s_cbranch_scc1 L_nrd
    v_mov_b32 v32, 1
    v_mov_b32 v33, 0
    s_waitcnt vmcnt(21)
    s_mov_b64 exec, 1
    buffer_store_dword v32, v33, s[40:43], 0 offen sc1
    s_mov_b64 exec, -1
L_nrd:
    s_and_b32 s95, s2, 3
    s_mul_i32 s3, s95, 5376
    s_sub_u32 s3, s47, s3
    s_lshr_b32 s45, s2, 2
    s_and_b32 s45, s45, 2
    s_xor_b32 s95, s95, s45
    s_and_b32 s45, s44, 1
    s_lshr_b32 s46, s44, 1
    s_mul_i32 s63, s46, 24576
    s_mov_b32 s62, 0
    v_and_b32 v16, 15, v0
    v_lshrrev_b32 v17, 4, v0
    s_mov_b32 s24, s12
    s_mov_b32 s25, s13
    s_mov_b32 s26, 9633792
    s_mov_b32 s27, 0x00020000
    v_and_b32 v21, 1, v16
    v_lshlrev_b32 v21, 4, v21
    v_mov_b32 v22, 0x3f80
    v_lshlrev_b32 v21, v21, v22
    v_lshrrev_b32 v22, 1, v16
    v_cmp_eq_u32 vcc, 0, v22
    s_nop 1
    v_cndmask_b32 v24, 0, v21, vcc
    v_cmp_eq_u32 vcc, 1, v22
    s_nop 1
    v_cndmask_b32 v25, 0, v21, vcc
    v_cmp_eq_u32 vcc, 2, v22
    s_nop 1
    v_cndmask_b32 v26, 0, v21, vcc
    v_cmp_eq_u32 vcc, 3, v22
    s_nop 1
    v_cndmask_b32 v27, 0, v21, vcc
    v_cmp_eq_u32 vcc, 4, v22
    s_nop 1
    v_cndmask_b32 v28, 0, v21, vcc
    v_cmp_eq_u32 vcc, 5, v22
    s_nop 1
    v_cndmask_b32 v29, 0, v21, vcc
    v_cmp_eq_u32 vcc, 6, v22
    s_nop 1
    v_cndmask_b32 v30, 0, v21, vcc
    v_cmp_eq_u32 vcc, 7, v22
    s_nop 1
    v_cndmask_b32 v31, 0, v21, vcc
    v_mov_b32 v8, 117504
    v_mov_b32 v9, 0
    ds_write_b32 v8, v9
    v_lshrrev_b32 v21, 1, v17
    v_mul_u32_u24 v21, 192, v21
    v_lshl_add_u32 v21, v16, 4, v21
    v_and_b32 v22, 1, v17
    v_lshl_add_u32 v21, v22, 3, v21
    s_mul_i32 s48, s44, 384
    s_add_u32 s48, s48, 116736
    v_add_u32 v21, s48, v21
    v_cmp_gt_u32 s[54:55], 12, v16
    s_sub_u32 s50, s50, 21504
    v_lshl_add_u32 v39, v16, 4, s50
    v_mul_u32_u24 v36, 192, v17
    v_add_u32 v36, v36, v39
    v_cmp_gt_u32 vcc, 3, v17
    v_add_u32 v39, 2688, v39
    v_add_u32 v37, 768, v36
    v_add_u32 v38, 2112, v36
    v_cndmask_b32 v37, v39, v37, vcc
    v_cndmask_b32 v38, v39, v38, vcc
    s_waitcnt vmcnt(18)
    ds_read_b128 v[120:123], v36 offset:0
    ds_read_b128 v[124:127], v37 offset:0
    ds_read_b128 v[128:131], v36 offset:1344
    ds_read_b128 v[132:135], v38 offset:0
    s_waitcnt vmcnt(15)
    ds_read_b128 v[136:139], v36 offset:3072
    ds_read_b128 v[140:143], v37 offset:3072
    ds_read_b128 v[144:147], v36 offset:4416
    ds_read_b128 v[148:151], v38 offset:3072
    s_waitcnt vmcnt(12)
    ds_read_b128 v[152:155], v36 offset:6144
    ds_read_b128 v[156:159], v37 offset:6144
    ds_read_b128 v[160:163], v36 offset:7488
    ds_read_b128 v[164:167], v38 offset:6144
    s_waitcnt lgkmcnt(8)
    v_mfma_f32_16x16x32_bf16 v[32:35], v[24:27], v[120:123], 0
    v_mfma_f32_16x16x32_bf16 v[32:35], v[24:27], v[124:127], v[32:35]
    v_mfma_f32_16x16x32_bf16 v[32:35], v[28:31], v[128:131], v[32:35]
    v_mfma_f32_16x16x32_bf16 v[32:35], v[28:31], v[132:135], v[32:35]
    s_waitcnt vmcnt(9)
    ds_read_b128 v[168:171], v36 offset:9216
    ds_read_b128 v[172:175], v37 offset:9216
    ds_read_b128 v[176:179], v36 offset:10560
    ds_read_b128 v[180:183], v38 offset:9216
    s_waitcnt lgkmcnt(8)
    v_mfma_f32_16x16x32_bf16 v[32:35], v[24:27], v[136:139], v[32:35]
    v_mfma_f32_16x16x32_bf16 v[32:35], v[24:27], v[140:143], v[32:35]
    v_mfma_f32_16x16x32_bf16 v[32:35], v[28:31], v[144:147], v[32:35]
    v_mfma_f32_16x16x32_bf16 v[32:35], v[28:31], v[148:151], v[32:35]
    s_waitcnt vmcnt(6)
    ds_read_b128 v[184:187], v36 offset:12288
    ds_read_b128 v[188:191], v37 offset:12288
    ds_read_b128 v[192:195], v36 offset:13632
    ds_read_b128 v[196:199], v38 offset:12288
    s_waitcnt lgkmcnt(8)
    v_mfma_f32_16x16x32_bf16 v[32:35], v[24:27], v[152:155], v[32:35]
    v_mfma_f32_16x16x32_bf16 v[32:35], v[24:27], v[156:159], v[32:35]
    v_mfma_f32_16x16x32_bf16 v[32:35], v[28:31], v[160:163], v[32:35]
    v_mfma_f32_16x16x32_bf16 v[32:35], v[28:31], v[164:167], v[32:35]
    s_waitcnt vmcnt(3)
    ds_read_b128 v[200:203], v36 offset:15360
    ds_read_b128 v[204:207], v37 offset:15360
    ds_read_b128 v[208:211], v36 offset:16704
    ds_read_b128 v[212:215], v38 offset:15360
    s_waitcnt lgkmcnt(8)
    v_mfma_f32_16x16x32_bf16 v[32:35], v[24:27], v[168:171], v[32:35]
    v_mfma_f32_16x16x32_bf16 v[32:35], v[24:27], v[172:175], v[32:35]
    v_mfma_f32_16x16x32_bf16 v[32:35], v[28:31], v[176:179], v[32:35]
    v_mfma_f32_16x16x32_bf16 v[32:35], v[28:31], v[180:183], v[32:35]
    s_waitcnt vmcnt(0)
    ds_read_b128 v[216:219], v36 offset:18432
    ds_read_b128 v[220:223], v37 offset:18432
    ds_read_b128 v[224:227], v36 offset:19776
    ds_read_b128 v[228:231], v38 offset:18432
    s_waitcnt lgkmcnt(8)
    v_mfma_f32_16x16x32_bf16 v[32:35], v[24:27], v[184:187], v[32:35]
    v_mfma_f32_16x16x32_bf16 v[32:35], v[24:27], v[188:191], v[32:35]
    v_mfma_f32_16x16x32_bf16 v[32:35], v[28:31], v[192:195], v[32:35]
    v_mfma_f32_16x16x32_bf16 v[32:35], v[28:31], v[196:199], v[32:35]
    s_waitcnt lgkmcnt(4)
    v_mfma_f32_16x16x32_bf16 v[32:35], v[24:27], v[200:203], v[32:35]
    v_mfma_f32_16x16x32_bf16 v[32:35], v[24:27], v[204:207], v[32:35]
    v_mfma_f32_16x16x32_bf16 v[32:35], v[28:31], v[208:211], v[32:35]
    v_mfma_f32_16x16x32_bf16 v[32:35], v[28:31], v[212:215], v[32:35]
    s_waitcnt lgkmcnt(3)
    v_mfma_f32_16x16x32_bf16 v[32:35], v[24:27], v[216:219], v[32:35]
    s_waitcnt lgkmcnt(2)
    v_mfma_f32_16x16x32_bf16 v[32:35], v[24:27], v[220:223], v[32:35]
    s_waitcnt lgkmcnt(1)
    v_mfma_f32_16x16x32_bf16 v[32:35], v[28:31], v[224:227], v[32:35]
    s_waitcnt lgkmcnt(0)
    v_mfma_f32_16x16x32_bf16 v[32:35], v[28:31], v[228:231], v[32:35]
    s_nop 7
    v_mul_f32 v32, 0x3ca72f05, v32
    v_mul_f32 v33, 0x3ca72f05, v33
    v_mul_f32 v34, 0x3ca72f05, v34
    v_mul_f32 v35, 0x3ca72f05, v35
    v_cvt_pk_bf16_f32 v32, v32, v33
    v_cvt_pk_bf16_f32 v33, v34, v35
    s_mov_b64 exec, s[54:55]
    ds_write_b64 v21, v[32:33]
    s_mov_b64 exec, -1
    s_waitcnt lgkmcnt(0)
    s_barrier
    v_and_b32 v8, 15, v0
    v_lshrrev_b32 v9, 4, v0
    v_lshlrev_b32 v9, 4, v9
    v_lshlrev_b32 v90, 7, v8
    v_add_u32 v90, 528384, v90
    v_lshlrev_b32 v3, 4, v0
    v_add_u32 v4, 4096, v3
    v_add_u32 v5, 8192, v3
    s_mul_i32 s48, s44, 28672
    v_add_u32 v6, s48, v3
    s_xor_b32 s48, s44, 2
    s_mul_i32 s48, s48, 28672
    v_add_u32 v7, s48, v3
    s_mul_i32 s48, s45, 96
    s_mul_i32 s49, s46, 48
    s_add_u32 s50, s48, s49
    s_sub_u32 s49, 48, s49
    s_add_u32 s49, s48, s49
    s_mov_b32 s51, 37632
    s_mov_b32 s52, -2304
    s_mov_b32 s53, 18816
    v_add_u32 v13, 73728, v9
    s_add_u32 s48, s49, 0
    v_add_u32 v10, s48, v8
    v_mul_u32_u24 v11, 4682, v10
    v_mul_u32_u24 v10, 192, v10
    v_lshrrev_b32 v12, 17, v11
    v_bfe_u32 v11, v11, 16, 1
    v_mad_i32_i24 v10, v12, s52, v10
    v_mad_u32_u24 v10, v11, s53, v10
    v_add_u32 v92, v10, v13
    s_add_u32 s48, s49, 16
    v_add_u32 v10, s48, v8
    v_mul_u32_u24 v11, 4682, v10
    v_mul_u32_u24 v10, 192, v10
    v_lshrrev_b32 v12, 17, v11
    v_bfe_u32 v11, v11, 16, 1
    v_mad_i32_i24 v10, v12, s52, v10
    v_mad_u32_u24 v10, v11, s53, v10
    v_add_u32 v93, v10, v13
    s_add_u32 s48, s49, 32
    v_add_u32 v10, s48, v8
    v_mul_u32_u24 v11, 4682, v10
    v_mul_u32_u24 v10, 192, v10
    v_lshrrev_b32 v12, 17, v11
    v_bfe_u32 v11, v11, 16, 1
    v_mad_i32_i24 v10, v12, s52, v10
    v_mad_u32_u24 v10, v11, s53, v10
    v_add_u32 v94, v10, v13
    s_add_u32 s48, s50, 0
    v_add_u32 v10, s48, v8
    v_mul_u32_u24 v11, 4682, v10
    v_mul_u32_u24 v10, 192, v10
    v_lshrrev_b32 v12, 17, v11
    v_bfe_u32 v11, v11, 16, 1
    v_mad_u32_u24 v14, v12, s51, v10
    v_add_u32 v240, v14, v9
    v_mad_i32_i24 v10, v12, s52, v10
    v_mad_u32_u24 v10, v11, s53, v10
    v_add_u32 v95, v10, v13
    s_add_u32 s48, s50, 16
    v_add_u32 v10, s48, v8
    v_mul_u32_u24 v11, 4682, v10
    v_mul_u32_u24 v10, 192, v10
    v_lshrrev_b32 v12, 17, v11
    v_bfe_u32 v11, v11, 16, 1
    v_mad_u32_u24 v14, v12, s51, v10
    v_add_u32 v241, v14, v9
    v_mad_i32_i24 v10, v12, s52, v10
    v_mad_u32_u24 v10, v11, s53, v10
    v_add_u32 v96, v10, v13
    s_add_u32 s48, s50, 32
    v_add_u32 v10, s48, v8
    v_mul_u32_u24 v11, 4682, v10
    v_mul_u32_u24 v10, 192, v10
    v_lshrrev_b32 v12, 17, v11
    v_bfe_u32 v11, v11, 16, 1
    v_mad_u32_u24 v14, v12, s51, v10
    v_add_u32 v242, v14, v9
    v_mad_i32_i24 v10, v12, s52, v10
    v_mad_u32_u24 v10, v11, s53, v10
    v_add_u32 v97, v10, v13
    v_lshrrev_b32 v10, 2, v8
    v_and_b32 v11, 3, v8
    v_mul_u32_u24 v10, 5376, v10
    v_mul_u32_u24 v11, 192, v11
    v_add3_u32 v10, v10, v11, v9
    v_add_u32 v243, 262656, v10
    s_min_u32 s48, s44, 2
    s_lshl_b32 s48, s48, 11
    v_add_u32 v1, s48, v3
    s_mov_b32 s20, s4
    s_mov_b32 s21, s5
    s_mov_b32 s22, 9633792
    s_mov_b32 s23, 0x00020000
    buffer_load_dwordx4 a[168:171], v243, s[20:23], s3 offen offset:0
    buffer_load_dwordx4 a[172:175], v243, s[20:23], s3 offen offset:64
    buffer_load_dwordx4 a[176:179], v243, s[20:23], s3 offen offset:128
    ds_read_b128 a[96:99], v92 offset:0
    ds_read_b128 a[100:103], v92 offset:64
    ds_read_b128 a[104:107], v92 offset:128
    ds_read_b128 a[108:111], v93 offset:0
    ds_read_b128 a[112:115], v93 offset:64
    ds_read_b128 a[116:119], v93 offset:128
    ds_read_b128 a[120:123], v94 offset:0
    ds_read_b128 a[124:127], v94 offset:64
    ds_read_b128 a[128:131], v94 offset:128
    ds_read_b128 a[132:135], v95 offset:0
    ds_read_b128 a[136:139], v95 offset:64
    ds_read_b128 a[140:143], v95 offset:128
    ds_read_b128 a[144:147], v96 offset:0
    ds_read_b128 a[148:151], v96 offset:64
    ds_read_b128 a[152:155], v96 offset:128
    ds_read_b128 a[156:159], v97 offset:0
    ds_read_b128 a[160:163], v97 offset:64
    ds_read_b128 a[164:167], v97 offset:128
    v_mov_b32 v92, 0
    v_mov_b32 v93, 0
    v_mov_b32 v94, 0
    v_mov_b32 v95, 0
    v_mov_b32 v96, 0
    v_mov_b32 v97, 0
    v_mov_b32 v98, 0
    v_mov_b32 v99, 0
    v_mov_b32 v100, 0
    v_mov_b32 v101, 0
    v_mov_b32 v102, 0
    v_mov_b32 v103, 0
    v_mov_b32 v104, 0
    v_mov_b32 v105, 0
    v_mov_b32 v106, 0
    v_mov_b32 v107, 0
    v_mov_b32 v108, 0
    v_mov_b32 v109, 0
    v_mov_b32 v110, 0
    v_mov_b32 v111, 0
    v_mov_b32 v112, 0
    v_mov_b32 v113, 0
    v_mov_b32 v114, 0
    v_mov_b32 v115, 0
    v_mov_b32 v116, 0
    v_mov_b32 v117, 0
    v_mov_b32 v118, 0
    v_mov_b32 v119, 0
    v_accvgpr_write_b32 a0, 0
    v_accvgpr_write_b32 a1, 0
    v_accvgpr_write_b32 a2, 0
    v_accvgpr_write_b32 a3, 0
    v_accvgpr_write_b32 a4, 0
    v_accvgpr_write_b32 a5, 0
    v_accvgpr_write_b32 a6, 0
    v_accvgpr_write_b32 a7, 0
    v_accvgpr_write_b32 a8, 0
    v_accvgpr_write_b32 a9, 0
    v_accvgpr_write_b32 a10, 0
    v_accvgpr_write_b32 a11, 0
    v_accvgpr_write_b32 a12, 0
    v_accvgpr_write_b32 a13, 0
    v_accvgpr_write_b32 a14, 0
    v_accvgpr_write_b32 a15, 0
    v_accvgpr_write_b32 a16, 0
    v_accvgpr_write_b32 a17, 0
    v_accvgpr_write_b32 a18, 0
    v_accvgpr_write_b32 a19, 0
    v_accvgpr_write_b32 a20, 0
    v_accvgpr_write_b32 a21, 0
    v_accvgpr_write_b32 a22, 0
    v_accvgpr_write_b32 a23, 0
    v_accvgpr_write_b32 a24, 0
    v_accvgpr_write_b32 a25, 0
    v_accvgpr_write_b32 a26, 0
    v_accvgpr_write_b32 a27, 0
    v_accvgpr_write_b32 a28, 0
    v_accvgpr_write_b32 a29, 0
    v_accvgpr_write_b32 a30, 0
    v_accvgpr_write_b32 a31, 0
    v_accvgpr_write_b32 a32, 0
    v_accvgpr_write_b32 a33, 0
    v_accvgpr_write_b32 a34, 0
    v_accvgpr_write_b32 a35, 0
    v_accvgpr_write_b32 a36, 0
    v_accvgpr_write_b32 a37, 0
    v_accvgpr_write_b32 a38, 0
    v_accvgpr_write_b32 a39, 0
    v_accvgpr_write_b32 a40, 0
    v_accvgpr_write_b32 a41, 0
    v_accvgpr_write_b32 a42, 0
    v_accvgpr_write_b32 a43, 0
    v_accvgpr_write_b32 a44, 0
    v_accvgpr_write_b32 a45, 0
    v_accvgpr_write_b32 a46, 0
    v_accvgpr_write_b32 a47, 0
    v_accvgpr_write_b32 a48, 0
    v_accvgpr_write_b32 a49, 0
    v_accvgpr_write_b32 a50, 0
    v_accvgpr_write_b32 a51, 0
    v_accvgpr_write_b32 a52, 0
    v_accvgpr_write_b32 a53, 0
    v_accvgpr_write_b32 a54, 0
    v_accvgpr_write_b32 a55, 0
    v_accvgpr_write_b32 a56, 0
    v_accvgpr_write_b32 a57, 0
    v_accvgpr_write_b32 a58, 0
    v_accvgpr_write_b32 a59, 0
    v_accvgpr_write_b32 a60, 0
    v_accvgpr_write_b32 a61, 0
    v_accvgpr_write_b32 a62, 0
    v_accvgpr_write_b32 a63, 0
    v_accvgpr_write_b32 a64, 0
    v_accvgpr_write_b32 a65, 0
    v_accvgpr_write_b32 a66, 0
    v_accvgpr_write_b32 a67, 0
    v_accvgpr_write_b32 a68, 0
    v_accvgpr_write_b32 a69, 0
    v_accvgpr_write_b32 a70, 0
    v_accvgpr_write_b32 a71, 0
    v_accvgpr_write_b32 a72, 0
    v_accvgpr_write_b32 a73, 0
    v_accvgpr_write_b32 a74, 0
    v_accvgpr_write_b32 a75, 0
    v_accvgpr_write_b32 a76, 0
    v_accvgpr_write_b32 a77, 0
    v_accvgpr_write_b32 a78, 0
    v_accvgpr_write_b32 a79, 0
    v_accvgpr_write_b32 a80, 0
    v_accvgpr_write_b32 a81, 0
    v_accvgpr_write_b32 a82, 0
    v_accvgpr_write_b32 a83, 0
    v_accvgpr_write_b32 a84, 0
    v_accvgpr_write_b32 a85, 0
    v_accvgpr_write_b32 a86, 0
    v_accvgpr_write_b32 a87, 0
    v_accvgpr_write_b32 a88, 0
    v_accvgpr_write_b32 a89, 0
    v_accvgpr_write_b32 a90, 0
    v_accvgpr_write_b32 a91, 0
    v_accvgpr_write_b32 a92, 0
    v_accvgpr_write_b32 a93, 0
    v_accvgpr_write_b32 a94, 0
    v_accvgpr_write_b32 a95, 0
    v_accvgpr_write_b32 a228, 0
    v_accvgpr_write_b32 a229, 0
    v_accvgpr_write_b32 a230, 0
    v_accvgpr_write_b32 a231, 0
    v_accvgpr_write_b32 a232, 0
    v_accvgpr_write_b32 a233, 0
    v_accvgpr_write_b32 a234, 0
    v_accvgpr_write_b32 a235, 0
    v_accvgpr_write_b32 a236, 0
    v_accvgpr_write_b32 a237, 0
    v_accvgpr_write_b32 a238, 0
    v_accvgpr_write_b32 a239, 0
    v_accvgpr_write_b32 a240, 0
    v_accvgpr_write_b32 a241, 0
    v_accvgpr_write_b32 a242, 0
    v_accvgpr_write_b32 a243, 0
    v_accvgpr_write_b32 a244, 0
    v_accvgpr_write_b32 a245, 0
    v_accvgpr_write_b32 a246, 0
    v_accvgpr_write_b32 a247, 0
    v_accvgpr_write_b32 a248, 0
    v_accvgpr_write_b32 a249, 0
    v_accvgpr_write_b32 a250, 0
    v_accvgpr_write_b32 a251, 0
    v_accvgpr_write_b32 a252, 0
    v_accvgpr_write_b32 a253, 0
    v_accvgpr_write_b32 a254, 0
    v_accvgpr_write_b32 a255, 0
    v_mov_b32 v120, 0
    v_mov_b32 v121, 0
    v_mov_b32 v122, 0
    v_mov_b32 v123, 0
    v_mov_b32 v124, 0
    v_mov_b32 v125, 0
    v_mov_b32 v126, 0
    v_mov_b32 v127, 0
    v_mov_b32 v128, 0
    v_mov_b32 v129, 0
    v_mov_b32 v130, 0
    v_mov_b32 v131, 0
    v_mov_b32 v132, 0
    v_mov_b32 v133, 0
    v_mov_b32 v134, 0
    v_mov_b32 v135, 0
    v_mov_b32 v136, 0
    v_mov_b32 v137, 0
    v_mov_b32 v138, 0
    v_mov_b32 v139, 0
    v_mov_b32 v140, 0
    v_mov_b32 v141, 0
    v_mov_b32 v142, 0
    v_mov_b32 v143, 0
    v_mov_b32 v144, 0
    v_mov_b32 v145, 0
    v_mov_b32 v146, 0
    v_mov_b32 v147, 0
    v_mov_b32 v148, 0
    v_mov_b32 v149, 0
    v_mov_b32 v150, 0
    v_mov_b32 v151, 0
    v_mov_b32 v152, 0
    v_mov_b32 v153, 0
    v_mov_b32 v154, 0
    v_mov_b32 v155, 0
    v_mov_b32 v156, 0
    v_mov_b32 v157, 0
    v_mov_b32 v158, 0
    v_mov_b32 v159, 0
    v_mov_b32 v160, 0
    v_mov_b32 v161, 0
    v_mov_b32 v162, 0
    v_mov_b32 v163, 0
    v_mov_b32 v164, 0
    v_mov_b32 v165, 0
    v_mov_b32 v166, 0
    v_mov_b32 v167, 0
    v_mov_b32 v168, 0
    v_mov_b32 v169, 0
    v_mov_b32 v170, 0
    v_mov_b32 v171, 0
    v_mov_b32 v172, 0
    v_mov_b32 v173, 0
    v_mov_b32 v174, 0
    v_mov_b32 v175, 0
    v_mov_b32 v176, 0
    v_mov_b32 v177, 0
    v_mov_b32 v178, 0
    v_mov_b32 v179, 0
    v_mov_b32 v180, 0
    v_mov_b32 v181, 0
    v_mov_b32 v182, 0
    v_mov_b32 v183, 0
    v_mov_b32 v184, 0
    v_mov_b32 v185, 0
    v_mov_b32 v186, 0
    v_mov_b32 v187, 0
    v_mov_b32 v188, 0
    v_mov_b32 v189, 0
    v_mov_b32 v190, 0
    v_mov_b32 v191, 0
    s_branch L_go
L_poll:
    s_sleep 6
L_poll1:
    buffer_load_dwordx2 v[12:13], v10, s[28:31], 0 offen sc1
    s_sub_u32 s49, s49, 1
    s_cbranch_scc1 L_go
    s_waitcnt vmcnt(0)
L_chk:
    v_and_b32 v12, v12, v13
    v_cmp_ne_u32 vcc, 1, v12
    s_nop 1
    s_cbranch_vccnz L_poll
L_go:
    v_and_b32 v8, 1, v0
    v_mul_u32_u24 v8, 0xaaaa, v8
    v_add_u32 v88, 0x4444, v8
    v_mov_b32 v89, 1
    v_mov_b32 v84, 0x3f803f80
    v_mov_b32 v85, 0x3f803f80
    v_mov_b32 v86, 0x3f803f80
    v_mov_b32 v87, 0x3f803f80
    s_waitcnt lgkmcnt(0)
    s_barrier
L_pass:
    s_mov_b32 s60, s63
    buffer_load_dwordx4 a[180:183], v3, s[28:31], s60 offen offset:0
    buffer_load_dwordx4 a[184:187], v3, s[28:31], s60 offen offset:1024
    buffer_load_dwordx4 a[188:191], v3, s[28:31], s60 offen offset:2048
    buffer_load_dwordx4 a[192:195], v3, s[28:31], s60 offen offset:3072
    buffer_load_dwordx4 a[196:199], v4, s[28:31], s60 offen offset:0
    buffer_load_dwordx4 a[200:203], v4, s[28:31], s60 offen offset:1024
    buffer_load_dwordx4 v[192:195], v4, s[28:31], s60 offen offset:2048
    buffer_load_dwordx4 v[196:199], v4, s[28:31], s60 offen offset:3072
    buffer_load_dwordx4 v[200:203], v5, s[28:31], s60 offen offset:0
    buffer_load_dwordx4 v[204:207], v5, s[28:31], s60 offen offset:1024
    buffer_load_dwordx4 v[208:211], v5, s[28:31], s60 offen offset:2048
    buffer_load_dwordx4 v[212:215], v5, s[28:31], s60 offen offset:3072
    s_add_u32 s60, s60, 12288
    s_mov_b32 s61, 7
    s_waitcnt vmcnt(11)
    v_mfma_f32_16x16x32_bf16 v[8:11], a[180:183], a[96:99], v[92:95]
    s_waitcnt vmcnt(10)
    v_mfma_f32_16x16x32_bf16 v[8:11], a[184:187], a[100:103], v[8:11]
    s_waitcnt vmcnt(9)
    v_mfma_f32_16x16x32_bf16 v[8:11], a[188:191], a[104:107], v[8:11]
    v_mfma_f32_16x16x32_bf16 v[16:19], a[180:183], a[108:111], v[96:99]
    v_mfma_f32_16x16x32_bf16 v[16:19], a[184:187], a[112:115], v[16:19]
    v_mfma_f32_16x16x32_bf16 v[16:19], a[188:191], a[116:119], v[16:19]
    s_waitcnt vmcnt(6)
    v_mfma_f32_16x16x32_bf16 v[12:15], a[192:195], a[96:99], v[92:95]
    buffer_load_dwordx4 a[204:207], v3, s[28:31], s60 offen offset:0
    buffer_load_dwordx4 a[208:211], v3, s[28:31], s60 offen offset:1024
    v_mfma_f32_16x16x32_bf16 v[12:15], a[196:199], a[100:103], v[12:15]
    buffer_load_dwordx4 a[212:215], v3, s[28:31], s60 offen offset:2048
    buffer_load_dwordx4 a[216:219], v3, s[28:31], s60 offen offset:3072
    v_mfma_f32_16x16x32_bf16 v[12:15], a[200:203], a[104:107], v[12:15]
    buffer_load_dwordx4 a[220:223], v4, s[28:31], s60 offen offset:0
    buffer_load_dwordx4 a[224:227], v4, s[28:31], s60 offen offset:1024
    s_cmp_lg_u32 s95, 0
    s_nop 0
    v_exp_f32 v8, v8
    v_exp_f32 v9, v9
    v_mfma_f32_16x16x32_bf16 v[20:23], a[192:195], a[108:111], v[96:99]
    v_exp_f32 v10, v10
    v_exp_f32 v11, v11
    v_mfma_f32_16x16x32_bf16 v[20:23], a[196:199], a[112:115], v[20:23]
    s_nop 1
    v_exp_f32 v12, v12
    v_cvt_pk_bf16_f32 v32, v8, v9
    v_mfma_f32_16x16x32_bf16 v[20:23], a[200:203], a[116:119], v[20:23]
    v_cvt_pk_bf16_f32 v33, v10, v11
    v_exp_f32 v13, v13
    v_exp_f32 v14, v14
    v_exp_f32 v15, v15
    v_cvt_pk_bf16_f32 v34, v12, v13
    v_cvt_pk_bf16_f32 v35, v14, v15
    s_waitcnt vmcnt(6)
    s_cbranch_scc1 L_s2_2
    s_cmp_eq_u32 s45, 0
    s_cbranch_scc0 L_s2_1
    s_branch L_s2_0
L_fv0:
    buffer_load_dword v89, v90, s[28:31], 0 offen sc1
    s_branch L_fvb0
L_fv1:
    buffer_load_dword v89, v90, s[28:31], 0 offen sc1
    s_branch L_fvb1
L_fvNone:
    buffer_load_dword v89, v90, s[28:31], 0 offen sc1
    s_branch L_fvbNone
.p2align 6
L_loop0:
    v_mfma_f32_16x16x32_bf16 v[8:11], a[180:183], a[96:99], v[92:95]
    v_exp_f32 v24, v24
    v_mfma_f32_16x16x32_bf16 v[8:11], a[184:187], a[100:103], v[8:11]
    v_exp_f32 v25, v25
    v_mfma_f32_16x16x32_bf16 v[8:11], a[188:191], a[104:107], v[8:11]
    v_exp_f32 v26, v26
    v_mfma_f32_16x16x32_bf16 v[12:15], a[192:195], a[96:99], v[92:95]
    v_exp_f32 v27, v27
    v_mfma_f32_16x16x32_bf16 v[12:15], a[196:199], a[100:103], v[12:15]
    v_exp_f32 v28, v28
    v_mfma_f32_16x16x32_bf16 v[12:15], a[200:203], a[104:107], v[12:15]
    v_cvt_pk_bf16_f32 v76, v24, v25
    v_cvt_pk_bf16_f32 v77, v26, v27
    v_mfma_f32_16x16x32_bf16 v[144:147], v[216:219], v[68:71], v[144:147]
    v_exp_f32 v29, v29
    v_mfma_f32_16x16x32_bf16 v[148:151], v[220:223], v[68:71], v[148:151]
    v_exp_f32 v30, v30
    v_mfma_f32_16x16x32_bf16 v[152:155], v[224:227], v[68:71], v[152:155]
    v_exp_f32 v31, v31
    v_mfma_f32_16x16x32_bf16 v[156:159], v[228:231], v[68:71], v[156:159]
    buffer_load_dwordx4 a[212:215], v3, s[28:31], s60 offen offset:2048
    v_mfma_f32_16x16x32_bf16 v[160:163], v[232:235], v[68:71], v[160:163]
    v_cvt_pk_bf16_f32 v78, v28, v29
    v_cvt_pk_bf16_f32 v79, v30, v31
    v_mfma_f32_16x16x32_bf16 v[164:167], v[236:239], v[68:71], v[164:167]
    buffer_load_dwordx4 a[216:219], v3, s[28:31], s60 offen offset:3072
    v_smfmac_f32_16x16x64_bf16 a[244:247], v[84:87], v[64:71], v88
    v_mfma_f32_16x16x32_bf16 v[16:19], a[180:183], a[108:111], v[96:99]
    v_exp_f32 v8, v8
    v_mfma_f32_16x16x32_bf16 v[16:19], a[184:187], a[112:115], v[16:19]
    v_exp_f32 v9, v9
    v_mfma_f32_16x16x32_bf16 v[16:19], a[188:191], a[116:119], v[16:19]
    v_exp_f32 v10, v10
    v_mfma_f32_16x16x32_bf16 v[20:23], a[192:195], a[108:111], v[96:99]
    v_exp_f32 v11, v11
    v_mfma_f32_16x16x32_bf16 v[20:23], a[196:199], a[112:115], v[20:23]
    v_exp_f32 v12, v12
    v_mfma_f32_16x16x32_bf16 v[20:23], a[200:203], a[116:119], v[20:23]
    v_cvt_pk_bf16_f32 v32, v8, v9
    v_cvt_pk_bf16_f32 v33, v10, v11
    v_mfma_f32_16x16x32_bf16 v[168:171], v[216:219], v[76:79], v[168:171]
    v_exp_f32 v13, v13
    v_mfma_f32_16x16x32_bf16 v[172:175], v[220:223], v[76:79], v[172:175]
    v_exp_f32 v14, v14
    v_mfma_f32_16x16x32_bf16 v[176:179], v[224:227], v[76:79], v[176:179]
    v_exp_f32 v15, v15
    v_mfma_f32_16x16x32_bf16 v[180:183], v[228:231], v[76:79], v[180:183]
    buffer_load_dwordx4 a[220:223], v4, s[28:31], s60 offen offset:0
    v_mfma_f32_16x16x32_bf16 v[184:187], v[232:235], v[76:79], v[184:187]
    v_cvt_pk_bf16_f32 v34, v12, v13
    v_cvt_pk_bf16_f32 v35, v14, v15
    v_mfma_f32_16x16x32_bf16 v[188:191], v[236:239], v[76:79], v[188:191]
    buffer_load_dwordx4 a[224:227], v4, s[28:31], s60 offen offset:1024
    v_smfmac_f32_16x16x64_bf16 a[248:251], v[84:87], v[72:79], v88
    s_waitcnt vmcnt(6)
L_s2_0:
    v_mfma_f32_16x16x32_bf16 v[8:11], a[180:183], a[120:123], v[100:103]
    v_exp_f32 v16, v16
    v_mfma_f32_16x16x32_bf16 v[8:11], a[184:187], a[124:127], v[8:11]
    v_exp_f32 v17, v17
    v_mfma_f32_16x16x32_bf16 v[8:11], a[188:191], a[128:131], v[8:11]
    v_exp_f32 v18, v18
    v_mfma_f32_16x16x32_bf16 v[12:15], a[192:195], a[120:123], v[100:103]
    v_exp_f32 v19, v19
    v_mfma_f32_16x16x32_bf16 v[12:15], a[196:199], a[124:127], v[12:15]
    v_exp_f32 v20, v20
    v_mfma_f32_16x16x32_bf16 v[12:15], a[200:203], a[128:131], v[12:15]
    v_cvt_pk_bf16_f32 v40, v16, v17
    v_cvt_pk_bf16_f32 v41, v18, v19
    v_mfma_f32_16x16x32_bf16 a[0:3], v[192:195], v[32:35], a[0:3]
    v_exp_f32 v21, v21
    v_mfma_f32_16x16x32_bf16 a[4:7], v[196:199], v[32:35], a[4:7]
    v_exp_f32 v22, v22
    v_mfma_f32_16x16x32_bf16 a[8:11], v[200:203], v[32:35], a[8:11]
    v_exp_f32 v23, v23
    v_mfma_f32_16x16x32_bf16 a[12:15], v[204:207], v[32:35], a[12:15]
    buffer_load_dwordx4 v[216:219], v4, s[28:31], s60 offen offset:2048
    v_mfma_f32_16x16x32_bf16 a[16:19], v[208:211], v[32:35], a[16:19]
    v_cvt_pk_bf16_f32 v42, v20, v21
    v_cvt_pk_bf16_f32 v43, v22, v23
    v_mfma_f32_16x16x32_bf16 a[20:23], v[212:215], v[32:35], a[20:23]
    buffer_load_dwordx4 v[220:223], v4, s[28:31], s60 offen offset:3072
    v_mfma_f32_16x16x32_bf16 v[16:19], a[180:183], a[132:135], v[104:107]
    v_exp_f32 v8, v8
    v_mfma_f32_16x16x32_bf16 v[16:19], a[184:187], a[136:139], v[16:19]
    v_exp_f32 v9, v9
    v_mfma_f32_16x16x32_bf16 v[16:19], a[188:191], a[140:143], v[16:19]
    v_exp_f32 v10, v10
    v_mfma_f32_16x16x32_bf16 v[20:23], a[192:195], a[132:135], v[104:107]
    v_exp_f32 v11, v11
    v_mfma_f32_16x16x32_bf16 v[20:23], a[196:199], a[136:139], v[20:23]
    v_exp_f32 v12, v12
    v_mfma_f32_16x16x32_bf16 v[20:23], a[200:203], a[140:143], v[20:23]
    v_cvt_pk_bf16_f32 v48, v8, v9
    v_cvt_pk_bf16_f32 v49, v10, v11
    v_mfma_f32_16x16x32_bf16 a[24:27], v[192:195], v[40:43], a[24:27]
    v_exp_f32 v13, v13
    v_mfma_f32_16x16x32_bf16 a[28:31], v[196:199], v[40:43], a[28:31]
    v_exp_f32 v14, v14
    v_mfma_f32_16x16x32_bf16 a[32:35], v[200:203], v[40:43], a[32:35]
    v_exp_f32 v15, v15
    v_mfma_f32_16x16x32_bf16 a[36:39], v[204:207], v[40:43], a[36:39]
    buffer_load_dwordx4 v[224:227], v5, s[28:31], s60 offen offset:0
    v_mfma_f32_16x16x32_bf16 a[40:43], v[208:211], v[40:43], a[40:43]
    v_cvt_pk_bf16_f32 v50, v12, v13
    v_cvt_pk_bf16_f32 v51, v14, v15
    v_mfma_f32_16x16x32_bf16 a[44:47], v[212:215], v[40:43], a[44:47]
    buffer_load_dwordx4 v[228:231], v5, s[28:31], s60 offen offset:1024
    v_mfma_f32_16x16x32_bf16 v[8:11], a[180:183], a[144:147], v[108:111]
    v_exp_f32 v16, v16
    v_mfma_f32_16x16x32_bf16 v[8:11], a[184:187], a[148:151], v[8:11]
    v_exp_f32 v17, v17
    v_mfma_f32_16x16x32_bf16 v[8:11], a[188:191], a[152:155], v[8:11]
    v_exp_f32 v18, v18
    v_mfma_f32_16x16x32_bf16 v[12:15], a[192:195], a[144:147], v[108:111]
    v_exp_f32 v19, v19
    v_mfma_f32_16x16x32_bf16 v[12:15], a[196:199], a[148:151], v[12:15]
    v_exp_f32 v20, v20
    v_mfma_f32_16x16x32_bf16 v[12:15], a[200:203], a[152:155], v[12:15]
    v_cvt_pk_bf16_f32 v56, v16, v17
    v_cvt_pk_bf16_f32 v57, v18, v19
    v_mfma_f32_16x16x32_bf16 a[48:51], v[192:195], v[48:51], a[48:51]
    v_exp_f32 v21, v21
    v_mfma_f32_16x16x32_bf16 a[52:55], v[196:199], v[48:51], a[52:55]
    v_exp_f32 v22, v22
    v_mfma_f32_16x16x32_bf16 a[56:59], v[200:203], v[48:51], a[56:59]
    v_exp_f32 v23, v23
    v_mfma_f32_16x16x32_bf16 a[60:63], v[204:207], v[48:51], a[60:63]
    buffer_load_dwordx4 v[232:235], v5, s[28:31], s60 offen offset:2048
    v_mfma_f32_16x16x32_bf16 a[64:67], v[208:211], v[48:51], a[64:67]
    v_cvt_pk_bf16_f32 v58, v20, v21
    v_cvt_pk_bf16_f32 v59, v22, v23
    v_mfma_f32_16x16x32_bf16 a[68:71], v[212:215], v[48:51], a[68:71]
    buffer_load_dwordx4 v[236:239], v5, s[28:31], s60 offen offset:3072
    v_mfma_f32_16x16x32_bf16 v[16:19], a[180:183], a[156:159], v[112:115]
    v_exp_f32 v8, v8
    v_mfma_f32_16x16x32_bf16 v[16:19], a[184:187], a[160:163], v[16:19]
    v_exp_f32 v9, v9
    v_mfma_f32_16x16x32_bf16 v[16:19], a[188:191], a[164:167], v[16:19]
    v_exp_f32 v10, v10
    v_mfma_f32_16x16x32_bf16 v[20:23], a[192:195], a[156:159], v[112:115]
    v_exp_f32 v11, v11
    v_mfma_f32_16x16x32_bf16 v[20:23], a[196:199], a[160:163], v[20:23]
    v_exp_f32 v12, v12
    v_mfma_f32_16x16x32_bf16 v[20:23], a[200:203], a[164:167], v[20:23]
    v_cvt_pk_bf16_f32 v64, v8, v9
    v_cvt_pk_bf16_f32 v65, v10, v11
    v_mfma_f32_16x16x32_bf16 v[120:123], v[192:195], v[56:59], v[120:123]
    v_exp_f32 v13, v13
    v_mfma_f32_16x16x32_bf16 v[124:127], v[196:199], v[56:59], v[124:127]
    v_exp_f32 v14, v14
    v_mfma_f32_16x16x32_bf16 v[128:131], v[200:203], v[56:59], v[128:131]
    v_exp_f32 v15, v15
    v_mfma_f32_16x16x32_bf16 v[132:135], v[204:207], v[56:59], v[132:135]
    s_add_u32 s60, s60, 36864
    v_mfma_f32_16x16x32_bf16 v[136:139], v[208:211], v[56:59], v[136:139]
    v_cvt_pk_bf16_f32 v66, v12, v13
    v_cvt_pk_bf16_f32 v67, v14, v15
    v_mfma_f32_16x16x32_bf16 v[140:143], v[212:215], v[56:59], v[140:143]
    s_waitcnt vmcnt(6)
    v_mfma_f32_16x16x32_bf16 v[8:11], a[180:183], a[168:171], v[116:119]
    v_exp_f32 v16, v16
    v_mfma_f32_16x16x32_bf16 v[8:11], a[184:187], a[172:175], v[8:11]
    v_exp_f32 v17, v17
    v_mfma_f32_16x16x32_bf16 v[8:11], a[188:191], a[176:179], v[8:11]
    v_exp_f32 v18, v18
    v_mfma_f32_16x16x32_bf16 v[12:15], a[192:195], a[168:171], v[116:119]
    v_exp_f32 v19, v19
    v_mfma_f32_16x16x32_bf16 v[12:15], a[196:199], a[172:175], v[12:15]
    v_exp_f32 v20, v20
    v_mfma_f32_16x16x32_bf16 v[12:15], a[200:203], a[176:179], v[12:15]
    v_cvt_pk_bf16_f32 v72, v16, v17
    v_cvt_pk_bf16_f32 v73, v18, v19
    v_cmp_eq_u32 vcc, 0, v89
    v_mfma_f32_16x16x32_bf16 v[144:147], v[192:195], v[64:67], v[144:147]
    v_exp_f32 v21, v21
    v_mfma_f32_16x16x32_bf16 v[148:151], v[196:199], v[64:67], v[148:151]
    v_exp_f32 v22, v22
    s_cbranch_vccnz L_slow0
L_back0:
    v_mfma_f32_16x16x32_bf16 v[152:155], v[200:203], v[64:67], v[152:155]
    v_exp_f32 v23, v23
    v_mfma_f32_16x16x32_bf16 v[156:159], v[204:207], v[64:67], v[156:159]
    buffer_load_dwordx4 a[180:183], v3, s[28:31], s60 offen offset:0
    v_mfma_f32_16x16x32_bf16 v[160:163], v[208:211], v[64:67], v[160:163]
    v_cvt_pk_bf16_f32 v74, v20, v21
    v_cvt_pk_bf16_f32 v75, v22, v23
    v_mfma_f32_16x16x32_bf16 v[164:167], v[212:215], v[64:67], v[164:167]
    buffer_load_dwordx4 a[184:187], v3, s[28:31], s60 offen offset:1024
    v_mfma_f32_16x16x32_bf16 v[16:19], a[204:207], a[96:99], v[92:95]
    v_exp_f32 v8, v8
    v_mfma_f32_16x16x32_bf16 v[16:19], a[208:211], a[100:103], v[16:19]
    v_exp_f32 v9, v9
    v_mfma_f32_16x16x32_bf16 v[16:19], a[212:215], a[104:107], v[16:19]
    v_exp_f32 v10, v10
    v_mfma_f32_16x16x32_bf16 v[20:23], a[216:219], a[96:99], v[92:95]
    v_exp_f32 v11, v11
    v_mfma_f32_16x16x32_bf16 v[20:23], a[220:223], a[100:103], v[20:23]
    v_exp_f32 v12, v12
    v_mfma_f32_16x16x32_bf16 v[20:23], a[224:227], a[104:107], v[20:23]
    v_cvt_pk_bf16_f32 v80, v8, v9
    v_cvt_pk_bf16_f32 v81, v10, v11
    v_mfma_f32_16x16x32_bf16 v[168:171], v[192:195], v[72:75], v[168:171]
    v_exp_f32 v13, v13
    v_mfma_f32_16x16x32_bf16 v[172:175], v[196:199], v[72:75], v[172:175]
    v_exp_f32 v14, v14
    v_mfma_f32_16x16x32_bf16 v[176:179], v[200:203], v[72:75], v[176:179]
    v_exp_f32 v15, v15
    v_mfma_f32_16x16x32_bf16 v[180:183], v[204:207], v[72:75], v[180:183]
    buffer_load_dwordx4 a[188:191], v3, s[28:31], s60 offen offset:2048
    v_mfma_f32_16x16x32_bf16 v[184:187], v[208:211], v[72:75], v[184:187]
    v_cvt_pk_bf16_f32 v82, v12, v13
    v_cvt_pk_bf16_f32 v83, v14, v15
    v_mfma_f32_16x16x32_bf16 v[188:191], v[212:215], v[72:75], v[188:191]
    buffer_load_dwordx4 a[192:195], v3, s[28:31], s60 offen offset:3072
    v_mfma_f32_16x16x32_bf16 v[8:11], a[204:207], a[108:111], v[96:99]
    v_exp_f32 v16, v16
    v_mfma_f32_16x16x32_bf16 v[8:11], a[208:211], a[112:115], v[8:11]
    v_exp_f32 v17, v17
    v_mfma_f32_16x16x32_bf16 v[8:11], a[212:215], a[116:119], v[8:11]
    v_exp_f32 v18, v18
    v_mfma_f32_16x16x32_bf16 v[12:15], a[216:219], a[108:111], v[96:99]
    v_exp_f32 v19, v19
    v_mfma_f32_16x16x32_bf16 v[12:15], a[220:223], a[112:115], v[12:15]
    v_exp_f32 v20, v20
    v_mfma_f32_16x16x32_bf16 v[12:15], a[224:227], a[116:119], v[12:15]
    v_cvt_pk_bf16_f32 v36, v16, v17
    v_cvt_pk_bf16_f32 v37, v18, v19
    v_mfma_f32_16x16x32_bf16 a[72:75], v[192:195], v[80:83], a[72:75]
    v_exp_f32 v21, v21
    v_mfma_f32_16x16x32_bf16 a[76:79], v[196:199], v[80:83], a[76:79]
    v_exp_f32 v22, v22
    v_mfma_f32_16x16x32_bf16 a[80:83], v[200:203], v[80:83], a[80:83]
    v_exp_f32 v23, v23
    v_mfma_f32_16x16x32_bf16 a[84:87], v[204:207], v[80:83], a[84:87]
    buffer_load_dwordx4 a[196:199], v4, s[28:31], s60 offen offset:0
    v_mfma_f32_16x16x32_bf16 a[88:91], v[208:211], v[80:83], a[88:91]
    v_cvt_pk_bf16_f32 v38, v20, v21
    v_cvt_pk_bf16_f32 v39, v22, v23
    v_mfma_f32_16x16x32_bf16 a[92:95], v[212:215], v[80:83], a[92:95]
    buffer_load_dwordx4 a[200:203], v4, s[28:31], s60 offen offset:1024
    v_mfma_f32_16x16x32_bf16 a[252:255], v[84:87], v[80:83], a[252:255]
    s_waitcnt vmcnt(6)
    v_mfma_f32_16x16x32_bf16 v[16:19], a[204:207], a[120:123], v[100:103]
    v_exp_f32 v8, v8
    v_mfma_f32_16x16x32_bf16 v[16:19], a[208:211], a[124:127], v[16:19]
    v_exp_f32 v9, v9
    v_mfma_f32_16x16x32_bf16 v[16:19], a[212:215], a[128:131], v[16:19]
    v_exp_f32 v10, v10
    v_mfma_f32_16x16x32_bf16 v[20:23], a[216:219], a[120:123], v[100:103]
    v_exp_f32 v11, v11
    v_mfma_f32_16x16x32_bf16 v[20:23], a[220:223], a[124:127], v[20:23]
    v_exp_f32 v12, v12
    v_mfma_f32_16x16x32_bf16 v[20:23], a[224:227], a[128:131], v[20:23]
    v_cvt_pk_bf16_f32 v44, v8, v9
    v_cvt_pk_bf16_f32 v45, v10, v11
    v_mfma_f32_16x16x32_bf16 a[0:3], v[216:219], v[36:39], a[0:3]
    v_exp_f32 v13, v13
    v_mfma_f32_16x16x32_bf16 a[4:7], v[220:223], v[36:39], a[4:7]
    v_exp_f32 v14, v14
    v_mfma_f32_16x16x32_bf16 a[8:11], v[224:227], v[36:39], a[8:11]
    v_exp_f32 v15, v15
    v_mfma_f32_16x16x32_bf16 a[12:15], v[228:231], v[36:39], a[12:15]
    buffer_load_dwordx4 v[192:195], v4, s[28:31], s60 offen offset:2048
    v_mfma_f32_16x16x32_bf16 a[16:19], v[232:235], v[36:39], a[16:19]
    v_cvt_pk_bf16_f32 v46, v12, v13
    v_cvt_pk_bf16_f32 v47, v14, v15
    v_mfma_f32_16x16x32_bf16 a[20:23], v[236:239], v[36:39], a[20:23]
    buffer_load_dwordx4 v[196:199], v4, s[28:31], s60 offen offset:3072
    v_smfmac_f32_16x16x64_bf16 a[228:231], v[84:87], v[32:39], v88
    s_sub_u32 s61, s61, 1
    v_mfma_f32_16x16x32_bf16 v[8:11], a[204:207], a[132:135], v[104:107]
    v_exp_f32 v16, v16
    v_mfma_f32_16x16x32_bf16 v[8:11], a[208:211], a[136:139], v[8:11]
    v_exp_f32 v17, v17
    v_mfma_f32_16x16x32_bf16 v[8:11], a[212:215], a[140:143], v[8:11]
    v_exp_f32 v18, v18
    v_mfma_f32_16x16x32_bf16 v[12:15], a[216:219], a[132:135], v[104:107]
    v_exp_f32 v19, v19
    v_mfma_f32_16x16x32_bf16 v[12:15], a[220:223], a[136:139], v[12:15]
    v_exp_f32 v20, v20
    v_mfma_f32_16x16x32_bf16 v[12:15], a[224:227], a[140:143], v[12:15]
    v_cvt_pk_bf16_f32 v52, v16, v17
    v_cvt_pk_bf16_f32 v53, v18, v19
    v_mfma_f32_16x16x32_bf16 a[24:27], v[216:219], v[44:47], a[24:27]
    v_exp_f32 v21, v21
    v_mfma_f32_16x16x32_bf16 a[28:31], v[220:223], v[44:47], a[28:31]
    v_exp_f32 v22, v22
    v_mfma_f32_16x16x32_bf16 a[32:35], v[224:227], v[44:47], a[32:35]
    v_exp_f32 v23, v23
    v_mfma_f32_16x16x32_bf16 a[36:39], v[228:231], v[44:47], a[36:39]
    buffer_load_dwordx4 v[200:203], v5, s[28:31], s60 offen offset:0
    v_mfma_f32_16x16x32_bf16 a[40:43], v[232:235], v[44:47], a[40:43]
    v_cvt_pk_bf16_f32 v54, v20, v21
    v_cvt_pk_bf16_f32 v55, v22, v23
    v_mfma_f32_16x16x32_bf16 a[44:47], v[236:239], v[44:47], a[44:47]
    buffer_load_dwordx4 v[204:207], v5, s[28:31], s60 offen offset:1024
    v_smfmac_f32_16x16x64_bf16 a[232:235], v[84:87], v[40:47], v88
    s_cmp_eq_u32 s61, 6
    s_cbranch_scc1 L_fv0
L_fvb0:
    v_mfma_f32_16x16x32_bf16 v[16:19], a[204:207], a[144:147], v[108:111]
    v_exp_f32 v8, v8
    v_mfma_f32_16x16x32_bf16 v[16:19], a[208:211], a[148:151], v[16:19]
    v_exp_f32 v9, v9
    v_mfma_f32_16x16x32_bf16 v[16:19], a[212:215], a[152:155], v[16:19]
    v_exp_f32 v10, v10
    v_mfma_f32_16x16x32_bf16 v[20:23], a[216:219], a[144:147], v[108:111]
    v_exp_f32 v11, v11
    v_mfma_f32_16x16x32_bf16 v[20:23], a[220:223], a[148:151], v[20:23]
    v_exp_f32 v12, v12
    v_mfma_f32_16x16x32_bf16 v[20:23], a[224:227], a[152:155], v[20:23]
    v_cvt_pk_bf16_f32 v60, v8, v9
    v_cvt_pk_bf16_f32 v61, v10, v11
    v_mfma_f32_16x16x32_bf16 a[48:51], v[216:219], v[52:55], a[48:51]
    v_exp_f32 v13, v13
    v_mfma_f32_16x16x32_bf16 a[52:55], v[220:223], v[52:55], a[52:55]
    v_exp_f32 v14, v14
    v_mfma_f32_16x16x32_bf16 a[56:59], v[224:227], v[52:55], a[56:59]
    v_exp_f32 v15, v15
    v_mfma_f32_16x16x32_bf16 a[60:63], v[228:231], v[52:55], a[60:63]
    buffer_load_dwordx4 v[208:211], v5, s[28:31], s60 offen offset:2048
    v_mfma_f32_16x16x32_bf16 a[64:67], v[232:235], v[52:55], a[64:67]
    v_cvt_pk_bf16_f32 v62, v12, v13
    v_cvt_pk_bf16_f32 v63, v14, v15
    v_mfma_f32_16x16x32_bf16 a[68:71], v[236:239], v[52:55], a[68:71]
    buffer_load_dwordx4 v[212:215], v5, s[28:31], s60 offen offset:3072
    v_smfmac_f32_16x16x64_bf16 a[236:239], v[84:87], v[48:55], v88
    s_add_u32 s60, s60, 12288
    s_waitcnt vmcnt(6)
    v_mfma_f32_16x16x32_bf16 v[24:27], a[204:207], a[156:159], v[112:115]
    v_exp_f32 v16, v16
    v_mfma_f32_16x16x32_bf16 v[24:27], a[208:211], a[160:163], v[24:27]
    v_exp_f32 v17, v17
    v_mfma_f32_16x16x32_bf16 v[24:27], a[212:215], a[164:167], v[24:27]
    v_exp_f32 v18, v18
    v_mfma_f32_16x16x32_bf16 v[28:31], a[216:219], a[156:159], v[112:115]
    v_exp_f32 v19, v19
    v_mfma_f32_16x16x32_bf16 v[28:31], a[220:223], a[160:163], v[28:31]
    v_exp_f32 v20, v20
    v_mfma_f32_16x16x32_bf16 v[28:31], a[224:227], a[164:167], v[28:31]
    v_cvt_pk_bf16_f32 v68, v16, v17
    v_cvt_pk_bf16_f32 v69, v18, v19
    v_mfma_f32_16x16x32_bf16 v[120:123], v[216:219], v[60:63], v[120:123]
    v_exp_f32 v21, v21
    v_mfma_f32_16x16x32_bf16 v[124:127], v[220:223], v[60:63], v[124:127]
    v_exp_f32 v22, v22
    v_mfma_f32_16x16x32_bf16 v[128:131], v[224:227], v[60:63], v[128:131]
    v_exp_f32 v23, v23
    v_mfma_f32_16x16x32_bf16 v[132:135], v[228:231], v[60:63], v[132:135]
    buffer_load_dwordx4 a[204:207], v3, s[28:31], s60 offen offset:0
    v_mfma_f32_16x16x32_bf16 v[136:139], v[232:235], v[60:63], v[136:139]
    v_cvt_pk_bf16_f32 v70, v20, v21
    v_cvt_pk_bf16_f32 v71, v22, v23
    s_cmp_lg_u32 s61, 0
    v_mfma_f32_16x16x32_bf16 v[140:143], v[236:239], v[60:63], v[140:143]
    buffer_load_dwordx4 a[208:211], v3, s[28:31], s60 offen offset:1024
    v_smfmac_f32_16x16x64_bf16 a[240:243], v[84:87], v[56:63], v88
    s_cbranch_scc1 L_loop0
    v_mfma_f32_16x16x32_bf16 v[8:11], a[180:183], a[96:99], v[92:95]
    v_exp_f32 v24, v24
    v_mfma_f32_16x16x32_bf16 v[8:11], a[184:187], a[100:103], v[8:11]
    v_exp_f32 v25, v25
    v_mfma_f32_16x16x32_bf16 v[8:11], a[188:191], a[104:107], v[8:11]
    v_exp_f32 v26, v26
    v_mfma_f32_16x16x32_bf16 v[12:15], a[192:195], a[96:99], v[92:95]
    v_exp_f32 v27, v27
    v_mfma_f32_16x16x32_bf16 v[12:15], a[196:199], a[100:103], v[12:15]
    v_exp_f32 v28, v28
    v_mfma_f32_16x16x32_bf16 v[12:15], a[200:203], a[104:107], v[12:15]
    v_cvt_pk_bf16_f32 v76, v24, v25
    v_cvt_pk_bf16_f32 v77, v26, v27
    v_mfma_f32_16x16x32_bf16 v[144:147], v[216:219], v[68:71], v[144:147]
    v_exp_f32 v29, v29
    v_mfma_f32_16x16x32_bf16 v[148:151], v[220:223], v[68:71], v[148:151]
    v_exp_f32 v30, v30
    v_mfma_f32_16x16x32_bf16 v[152:155], v[224:227], v[68:71], v[152:155]
    v_exp_f32 v31, v31
    v_mfma_f32_16x16x32_bf16 v[156:159], v[228:231], v[68:71], v[156:159]
    buffer_load_dwordx4 a[212:215], v3, s[28:31], s60 offen offset:2048
    v_mfma_f32_16x16x32_bf16 v[160:163], v[232:235], v[68:71], v[160:163]
    v_cvt_pk_bf16_f32 v78, v28, v29
    v_cvt_pk_bf16_f32 v79, v30, v31
    v_mfma_f32_16x16x32_bf16 v[164:167], v[236:239], v[68:71], v[164:167]
    buffer_load_dwordx4 a[216:219], v3, s[28:31], s60 offen offset:3072
    v_smfmac_f32_16x16x64_bf16 a[244:247], v[84:87], v[64:71], v88
    v_mfma_f32_16x16x32_bf16 v[16:19], a[180:183], a[108:111], v[96:99]
    v_exp_f32 v8, v8
    v_mfma_f32_16x16x32_bf16 v[16:19], a[184:187], a[112:115], v[16:19]
    v_exp_f32 v9, v9
    v_mfma_f32_16x16x32_bf16 v[16:19], a[188:191], a[116:119], v[16:19]
    v_exp_f32 v10, v10
    v_mfma_f32_16x16x32_bf16 v[20:23], a[192:195], a[108:111], v[96:99]
    v_exp_f32 v11, v11
    v_mfma_f32_16x16x32_bf16 v[20:23], a[196:199], a[112:115], v[20:23]
    v_exp_f32 v12, v12
    v_mfma_f32_16x16x32_bf16 v[20:23], a[200:203], a[116:119], v[20:23]
    v_cvt_pk_bf16_f32 v32, v8, v9
    v_cvt_pk_bf16_f32 v33, v10, v11
    v_mfma_f32_16x16x32_bf16 v[168:171], v[216:219], v[76:79], v[168:171]
    v_exp_f32 v13, v13
    v_mfma_f32_16x16x32_bf16 v[172:175], v[220:223], v[76:79], v[172:175]
    v_exp_f32 v14, v14
    v_mfma_f32_16x16x32_bf16 v[176:179], v[224:227], v[76:79], v[176:179]
    v_exp_f32 v15, v15
    v_mfma_f32_16x16x32_bf16 v[180:183], v[228:231], v[76:79], v[180:183]
    buffer_load_dwordx4 a[220:223], v4, s[28:31], s60 offen offset:0
    v_mfma_f32_16x16x32_bf16 v[184:187], v[232:235], v[76:79], v[184:187]
    v_cvt_pk_bf16_f32 v34, v12, v13
    v_cvt_pk_bf16_f32 v35, v14, v15
    v_mfma_f32_16x16x32_bf16 v[188:191], v[236:239], v[76:79], v[188:191]
    buffer_load_dwordx4 a[224:227], v4, s[28:31], s60 offen offset:1024
    v_smfmac_f32_16x16x64_bf16 a[248:251], v[84:87], v[72:79], v88
    s_waitcnt vmcnt(6)
    v_mfma_f32_16x16x32_bf16 v[8:11], a[180:183], a[120:123], v[100:103]
    v_exp_f32 v16, v16
    v_mfma_f32_16x16x32_bf16 v[8:11], a[184:187], a[124:127], v[8:11]
    v_exp_f32 v17, v17
    v_mfma_f32_16x16x32_bf16 v[8:11], a[188:191], a[128:131], v[8:11]
    v_exp_f32 v18, v18
    v_mfma_f32_16x16x32_bf16 v[12:15], a[192:195], a[120:123], v[100:103]
    v_exp_f32 v19, v19
    v_mfma_f32_16x16x32_bf16 v[12:15], a[196:199], a[124:127], v[12:15]
    v_exp_f32 v20, v20
    v_mfma_f32_16x16x32_bf16 v[12:15], a[200:203], a[128:131], v[12:15]
    v_cvt_pk_bf16_f32 v40, v16, v17
    v_cvt_pk_bf16_f32 v41, v18, v19
    v_mfma_f32_16x16x32_bf16 a[0:3], v[192:195], v[32:35], a[0:3]
    v_exp_f32 v21, v21
    v_mfma_f32_16x16x32_bf16 a[4:7], v[196:199], v[32:35], a[4:7]
    v_exp_f32 v22, v22
    buffer_load_dwordx4 v[216:219], v4, s[28:31], s60 offen offset:2048
    v_mfma_f32_16x16x32_bf16 a[8:11], v[200:203], v[32:35], a[8:11]
    v_exp_f32 v23, v23
    v_mfma_f32_16x16x32_bf16 a[12:15], v[204:207], v[32:35], a[12:15]
    buffer_load_dwordx4 v[220:223], v4, s[28:31], s60 offen offset:3072
    v_mfma_f32_16x16x32_bf16 a[16:19], v[208:211], v[32:35], a[16:19]
    v_cvt_pk_bf16_f32 v42, v20, v21
    v_cvt_pk_bf16_f32 v43, v22, v23
    v_mfma_f32_16x16x32_bf16 a[20:23], v[212:215], v[32:35], a[20:23]
    buffer_load_dwordx4 v[224:227], v5, s[28:31], s60 offen offset:0
    v_mfma_f32_16x16x32_bf16 v[16:19], a[180:183], a[132:135], v[104:107]
    v_exp_f32 v8, v8
    v_mfma_f32_16x16x32_bf16 v[16:19], a[184:187], a[136:139], v[16:19]
    v_exp_f32 v9, v9
    v_mfma_f32_16x16x32_bf16 v[16:19], a[188:191], a[140:143], v[16:19]
    v_exp_f32 v10, v10
    v_mfma_f32_16x16x32_bf16 v[20:23], a[192:195], a[132:135], v[104:107]
    v_exp_f32 v11, v11
    v_mfma_f32_16x16x32_bf16 v[20:23], a[196:199], a[136:139], v[20:23]
    v_exp_f32 v12, v12
    v_mfma_f32_16x16x32_bf16 v[20:23], a[200:203], a[140:143], v[20:23]
    v_cvt_pk_bf16_f32 v48, v8, v9
    v_cvt_pk_bf16_f32 v49, v10, v11
    v_mfma_f32_16x16x32_bf16 a[24:27], v[192:195], v[40:43], a[24:27]
    v_exp_f32 v13, v13
    v_mfma_f32_16x16x32_bf16 a[28:31], v[196:199], v[40:43], a[28:31]
    v_exp_f32 v14, v14
    buffer_load_dwordx4 v[228:231], v5, s[28:31], s60 offen offset:1024
    v_mfma_f32_16x16x32_bf16 a[32:35], v[200:203], v[40:43], a[32:35]
    v_exp_f32 v15, v15
    v_mfma_f32_16x16x32_bf16 a[36:39], v[204:207], v[40:43], a[36:39]
    buffer_load_dwordx4 v[232:235], v5, s[28:31], s60 offen offset:2048
    v_mfma_f32_16x16x32_bf16 a[40:43], v[208:211], v[40:43], a[40:43]
    v_cvt_pk_bf16_f32 v50, v12, v13
    v_cvt_pk_bf16_f32 v51, v14, v15
    v_mfma_f32_16x16x32_bf16 a[44:47], v[212:215], v[40:43], a[44:47]
    buffer_load_dwordx4 v[236:239], v5, s[28:31], s60 offen offset:3072
    s_waitcnt vmcnt(6)
    v_mfma_f32_16x16x32_bf16 v[8:11], a[204:207], a[96:99], v[92:95]
    v_exp_f32 v16, v16
    v_mfma_f32_16x16x32_bf16 v[8:11], a[208:211], a[100:103], v[8:11]
    v_exp_f32 v17, v17
    v_mfma_f32_16x16x32_bf16 v[8:11], a[212:215], a[104:107], v[8:11]
    v_exp_f32 v18, v18
    v_mfma_f32_16x16x32_bf16 v[12:15], a[216:219], a[96:99], v[92:95]
    v_exp_f32 v19, v19
    v_mfma_f32_16x16x32_bf16 v[12:15], a[220:223], a[100:103], v[12:15]
    v_exp_f32 v20, v20
    v_mfma_f32_16x16x32_bf16 v[12:15], a[224:227], a[104:107], v[12:15]
    v_cvt_pk_bf16_f32 v56, v16, v17
    v_cvt_pk_bf16_f32 v57, v18, v19
    v_mfma_f32_16x16x32_bf16 a[48:51], v[192:195], v[48:51], a[48:51]
    v_exp_f32 v21, v21
    v_mfma_f32_16x16x32_bf16 a[52:55], v[196:199], v[48:51], a[52:55]
    v_exp_f32 v22, v22
    v_mfma_f32_16x16x32_bf16 a[56:59], v[200:203], v[48:51], a[56:59]
    v_exp_f32 v23, v23
    v_mfma_f32_16x16x32_bf16 a[60:63], v[204:207], v[48:51], a[60:63]
    v_mfma_f32_16x16x32_bf16 a[64:67], v[208:211], v[48:51], a[64:67]
    v_cvt_pk_bf16_f32 v58, v20, v21
    v_cvt_pk_bf16_f32 v59, v22, v23
    v_mfma_f32_16x16x32_bf16 a[68:71], v[212:215], v[48:51], a[68:71]
    v_mfma_f32_16x16x32_bf16 v[16:19], a[204:207], a[108:111], v[96:99]
    v_exp_f32 v8, v8
    v_mfma_f32_16x16x32_bf16 v[16:19], a[208:211], a[112:115], v[16:19]
    v_exp_f32 v9, v9
    v_mfma_f32_16x16x32_bf16 v[16:19], a[212:215], a[116:119], v[16:19]
    v_exp_f32 v10, v10
    v_mfma_f32_16x16x32_bf16 v[20:23], a[216:219], a[108:111], v[96:99]
    v_exp_f32 v11, v11
    v_mfma_f32_16x16x32_bf16 v[20:23], a[220:223], a[112:115], v[20:23]
    v_exp_f32 v12, v12
    v_mfma_f32_16x16x32_bf16 v[20:23], a[224:227], a[116:119], v[20:23]
    v_cvt_pk_bf16_f32 v36, v8, v9
    v_cvt_pk_bf16_f32 v37, v10, v11
    v_mfma_f32_16x16x32_bf16 v[120:123], v[192:195], v[56:59], v[120:123]
    v_exp_f32 v13, v13
    v_mfma_f32_16x16x32_bf16 v[124:127], v[196:199], v[56:59], v[124:127]
    v_exp_f32 v14, v14
    v_mfma_f32_16x16x32_bf16 v[128:131], v[200:203], v[56:59], v[128:131]
    v_exp_f32 v15, v15
    v_mfma_f32_16x16x32_bf16 v[132:135], v[204:207], v[56:59], v[132:135]
    v_mfma_f32_16x16x32_bf16 v[136:139], v[208:211], v[56:59], v[136:139]
    v_cvt_pk_bf16_f32 v38, v12, v13
    v_cvt_pk_bf16_f32 v39, v14, v15
    v_mfma_f32_16x16x32_bf16 v[140:143], v[212:215], v[56:59], v[140:143]
    v_mfma_f32_16x16x32_bf16 v[8:11], a[204:207], a[120:123], v[100:103]
    v_exp_f32 v16, v16
    v_mfma_f32_16x16x32_bf16 v[8:11], a[208:211], a[124:127], v[8:11]
    v_exp_f32 v17, v17
    v_mfma_f32_16x16x32_bf16 v[8:11], a[212:215], a[128:131], v[8:11]
    v_exp_f32 v18, v18
    v_mfma_f32_16x16x32_bf16 v[12:15], a[216:219], a[120:123], v[100:103]
    v_exp_f32 v19, v19
    v_mfma_f32_16x16x32_bf16 v[12:15], a[220:223], a[124:127], v[12:15]
    v_exp_f32 v20, v20
    v_mfma_f32_16x16x32_bf16 v[12:15], a[224:227], a[128:131], v[12:15]
    v_cvt_pk_bf16_f32 v44, v16, v17
    v_cvt_pk_bf16_f32 v45, v18, v19
    s_waitcnt vmcnt(0)
    v_mfma_f32_16x16x32_bf16 a[0:3], v[216:219], v[36:39], a[0:3]
    v_exp_f32 v21, v21
    v_mfma_f32_16x16x32_bf16 a[4:7], v[220:223], v[36:39], a[4:7]
    v_exp_f32 v22, v22
    v_mfma_f32_16x16x32_bf16 a[8:11], v[224:227], v[36:39], a[8:11]
    v_exp_f32 v23, v23
    v_mfma_f32_16x16x32_bf16 a[12:15], v[228:231], v[36:39], a[12:15]
    v_mfma_f32_16x16x32_bf16 a[16:19], v[232:235], v[36:39], a[16:19]
    v_cvt_pk_bf16_f32 v46, v20, v21
    v_cvt_pk_bf16_f32 v47, v22, v23
    v_mfma_f32_16x16x32_bf16 a[20:23], v[236:239], v[36:39], a[20:23]
    ds_write_b128 v6, a[0:3] offset:0
    v_smfmac_f32_16x16x64_bf16 a[228:231], v[84:87], v[32:39], v88
    ds_write_b128 v6, a[4:7] offset:1024
    v_mfma_f32_16x16x32_bf16 v[16:19], a[180:183], a[168:171], v[116:119]
    v_exp_f32 v8, v8
    v_mfma_f32_16x16x32_bf16 v[16:19], a[184:187], a[172:175], v[16:19]
    v_exp_f32 v9, v9
    v_mfma_f32_16x16x32_bf16 v[16:19], a[188:191], a[176:179], v[16:19]
    v_exp_f32 v10, v10
    ds_write_b128 v6, a[8:11] offset:2048
    v_mfma_f32_16x16x32_bf16 v[20:23], a[192:195], a[168:171], v[116:119]
    v_exp_f32 v11, v11
    v_mfma_f32_16x16x32_bf16 v[20:23], a[196:199], a[172:175], v[20:23]
    v_exp_f32 v12, v12
    v_mfma_f32_16x16x32_bf16 v[20:23], a[200:203], a[176:179], v[20:23]
    v_cvt_pk_bf16_f32 v52, v8, v9
    v_cvt_pk_bf16_f32 v53, v10, v11
    ds_write_b128 v6, a[12:15] offset:3072
    v_mfma_f32_16x16x32_bf16 a[24:27], v[216:219], v[44:47], a[24:27]
    v_exp_f32 v13, v13
    v_mfma_f32_16x16x32_bf16 a[28:31], v[220:223], v[44:47], a[28:31]
    v_exp_f32 v14, v14
    v_mfma_f32_16x16x32_bf16 a[32:35], v[224:227], v[44:47], a[32:35]
    v_exp_f32 v15, v15
    v_mfma_f32_16x16x32_bf16 a[36:39], v[228:231], v[44:47], a[36:39]
    ds_write_b128 v6, a[16:19] offset:4096
    v_mfma_f32_16x16x32_bf16 a[40:43], v[232:235], v[44:47], a[40:43]
    v_cvt_pk_bf16_f32 v54, v12, v13
    v_cvt_pk_bf16_f32 v55, v14, v15
    v_mfma_f32_16x16x32_bf16 a[44:47], v[236:239], v[44:47], a[44:47]
    ds_write_b128 v6, a[20:23] offset:5120
    ds_write_b64 v6, a[228:229] offset:24576
    v_smfmac_f32_16x16x64_bf16 a[232:235], v[84:87], v[40:47], v88
    ds_write_b128 v6, a[24:27] offset:6144
    v_mfma_f32_16x16x32_bf16 v[8:11], a[180:183], a[144:147], v[108:111]
    v_exp_f32 v16, v16
    v_mfma_f32_16x16x32_bf16 v[8:11], a[184:187], a[148:151], v[8:11]
    v_exp_f32 v17, v17
    v_mfma_f32_16x16x32_bf16 v[8:11], a[188:191], a[152:155], v[8:11]
    v_exp_f32 v18, v18
    ds_write_b128 v6, a[28:31] offset:7168
    v_mfma_f32_16x16x32_bf16 v[12:15], a[192:195], a[144:147], v[108:111]
    v_exp_f32 v19, v19
    v_mfma_f32_16x16x32_bf16 v[12:15], a[196:199], a[148:151], v[12:15]
    v_exp_f32 v20, v20
    v_mfma_f32_16x16x32_bf16 v[12:15], a[200:203], a[152:155], v[12:15]
    v_cvt_pk_bf16_f32 v80, v16, v17
    v_cvt_pk_bf16_f32 v81, v18, v19
    ds_write_b128 v6, a[32:35] offset:8192
    v_mfma_f32_16x16x32_bf16 a[48:51], v[216:219], v[52:55], a[48:51]
    v_exp_f32 v21, v21
    v_mfma_f32_16x16x32_bf16 a[52:55], v[220:223], v[52:55], a[52:55]
    v_exp_f32 v22, v22
    v_mfma_f32_16x16x32_bf16 a[56:59], v[224:227], v[52:55], a[56:59]
    v_exp_f32 v23, v23
    v_mfma_f32_16x16x32_bf16 a[60:63], v[228:231], v[52:55], a[60:63]
    ds_write_b128 v6, a[36:39] offset:9216
    v_mfma_f32_16x16x32_bf16 a[64:67], v[232:235], v[52:55], a[64:67]
    v_cvt_pk_bf16_f32 v82, v20, v21
    v_cvt_pk_bf16_f32 v83, v22, v23
    v_mfma_f32_16x16x32_bf16 a[68:71], v[236:239], v[52:55], a[68:71]
    ds_write_b128 v6, a[40:43] offset:10240
    v_smfmac_f32_16x16x64_bf16 a[236:239], v[84:87], v[48:55], v88
    ds_write_b128 v6, a[44:47] offset:11264
    ds_write_b64 v6, a[232:233] offset:25600
    v_mfma_f32_16x16x32_bf16 v[16:19], a[180:183], a[156:159], v[112:115]
    v_exp_f32 v8, v8
    v_mfma_f32_16x16x32_bf16 v[16:19], a[184:187], a[160:163], v[16:19]
    v_exp_f32 v9, v9
    v_mfma_f32_16x16x32_bf16 v[16:19], a[188:191], a[164:167], v[16:19]
    v_exp_f32 v10, v10
    ds_write_b128 v6, a[48:51] offset:12288
    v_mfma_f32_16x16x32_bf16 v[20:23], a[192:195], a[156:159], v[112:115]
    v_exp_f32 v11, v11
    v_mfma_f32_16x16x32_bf16 v[20:23], a[196:199], a[160:163], v[20:23]
    v_exp_f32 v12, v12
    v_mfma_f32_16x16x32_bf16 v[20:23], a[200:203], a[164:167], v[20:23]
    v_cvt_pk_bf16_f32 v64, v8, v9
    v_cvt_pk_bf16_f32 v65, v10, v11
    ds_write_b128 v6, a[52:55] offset:13312
    v_mfma_f32_16x16x32_bf16 a[72:75], v[192:195], v[80:83], a[72:75]
    v_exp_f32 v13, v13
    v_mfma_f32_16x16x32_bf16 a[76:79], v[196:199], v[80:83], a[76:79]
    v_exp_f32 v14, v14
    v_mfma_f32_16x16x32_bf16 a[80:83], v[200:203], v[80:83], a[80:83]
    v_exp_f32 v15, v15
    v_mfma_f32_16x16x32_bf16 a[84:87], v[204:207], v[80:83], a[84:87]
    ds_write_b128 v6, a[56:59] offset:14336
    v_mfma_f32_16x16x32_bf16 a[88:91], v[208:211], v[80:83], a[88:91]
    v_cvt_pk_bf16_f32 v66, v12, v13
    v_cvt_pk_bf16_f32 v67, v14, v15
    v_mfma_f32_16x16x32_bf16 a[92:95], v[212:215], v[80:83], a[92:95]
    ds_write_b128 v6, a[60:63] offset:15360
    v_mfma_f32_16x16x32_bf16 a[252:255], v[84:87], v[80:83], a[252:255]
    ds_write_b128 v6, a[64:67] offset:16384
    v_mfma_f32_16x16x32_bf16 v[8:11], a[204:207], a[132:135], v[104:107]
    v_exp_f32 v16, v16
    v_mfma_f32_16x16x32_bf16 v[8:11], a[208:211], a[136:139], v[8:11]
    v_exp_f32 v17, v17
    v_mfma_f32_16x16x32_bf16 v[8:11], a[212:215], a[140:143], v[8:11]
    v_exp_f32 v18, v18
    ds_write_b128 v6, a[68:71] offset:17408
    ds_write_b64 v6, a[236:237] offset:26624
    v_mfma_f32_16x16x32_bf16 v[12:15], a[216:219], a[132:135], v[104:107]
    v_exp_f32 v19, v19
    v_mfma_f32_16x16x32_bf16 v[12:15], a[220:223], a[136:139], v[12:15]
    v_exp_f32 v20, v20
    v_mfma_f32_16x16x32_bf16 v[12:15], a[224:227], a[140:143], v[12:15]
    v_cvt_pk_bf16_f32 v72, v16, v17
    v_cvt_pk_bf16_f32 v73, v18, v19
    ds_write_b128 v6, a[72:75] offset:18432
    v_mfma_f32_16x16x32_bf16 v[144:147], v[192:195], v[64:67], v[144:147]
    v_exp_f32 v21, v21
    v_mfma_f32_16x16x32_bf16 v[148:151], v[196:199], v[64:67], v[148:151]
    v_exp_f32 v22, v22
    v_mfma_f32_16x16x32_bf16 v[152:155], v[200:203], v[64:67], v[152:155]
    v_exp_f32 v23, v23
    v_mfma_f32_16x16x32_bf16 v[156:159], v[204:207], v[64:67], v[156:159]
    ds_write_b128 v6, a[76:79] offset:19456
    v_mfma_f32_16x16x32_bf16 v[160:163], v[208:211], v[64:67], v[160:163]
    v_cvt_pk_bf16_f32 v74, v20, v21
    v_cvt_pk_bf16_f32 v75, v22, v23
    v_mfma_f32_16x16x32_bf16 v[164:167], v[212:215], v[64:67], v[164:167]
    ds_write_b128 v6, a[80:83] offset:20480
    v_mfma_f32_16x16x32_bf16 v[16:19], a[204:207], a[144:147], v[108:111]
    v_exp_f32 v8, v8
    v_mfma_f32_16x16x32_bf16 v[16:19], a[208:211], a[148:151], v[16:19]
    v_exp_f32 v9, v9
    v_mfma_f32_16x16x32_bf16 v[16:19], a[212:215], a[152:155], v[16:19]
    v_exp_f32 v10, v10
    ds_write_b128 v6, a[84:87] offset:21504
    v_mfma_f32_16x16x32_bf16 v[20:23], a[216:219], a[144:147], v[108:111]
    v_exp_f32 v11, v11
    v_mfma_f32_16x16x32_bf16 v[20:23], a[220:223], a[148:151], v[20:23]
    v_exp_f32 v12, v12
    v_mfma_f32_16x16x32_bf16 v[20:23], a[224:227], a[152:155], v[20:23]
    v_cvt_pk_bf16_f32 v60, v8, v9
    v_cvt_pk_bf16_f32 v61, v10, v11
    ds_write_b128 v6, a[88:91] offset:22528
    v_mfma_f32_16x16x32_bf16 v[168:171], v[192:195], v[72:75], v[168:171]
    v_exp_f32 v13, v13
    v_mfma_f32_16x16x32_bf16 v[172:175], v[196:199], v[72:75], v[172:175]
    v_exp_f32 v14, v14
    v_mfma_f32_16x16x32_bf16 v[176:179], v[200:203], v[72:75], v[176:179]
    v_exp_f32 v15, v15
    v_mfma_f32_16x16x32_bf16 v[180:183], v[204:207], v[72:75], v[180:183]
    ds_write_b128 v6, a[92:95] offset:23552
    ds_write_b32 v6, a252 offset:27648
    v_mfma_f32_16x16x32_bf16 v[184:187], v[208:211], v[72:75], v[184:187]
    v_cvt_pk_bf16_f32 v62, v12, v13
    v_cvt_pk_bf16_f32 v63, v14, v15
    v_mfma_f32_16x16x32_bf16 v[188:191], v[212:215], v[72:75], v[188:191]
    v_mfma_f32_16x16x32_bf16 v[24:27], a[204:207], a[156:159], v[112:115]
    v_exp_f32 v16, v16
    v_mfma_f32_16x16x32_bf16 v[24:27], a[208:211], a[160:163], v[24:27]
    v_exp_f32 v17, v17
    v_mfma_f32_16x16x32_bf16 v[24:27], a[212:215], a[164:167], v[24:27]
    v_exp_f32 v18, v18
    v_mfma_f32_16x16x32_bf16 v[28:31], a[216:219], a[156:159], v[112:115]
    v_exp_f32 v19, v19
    v_mfma_f32_16x16x32_bf16 v[28:31], a[220:223], a[160:163], v[28:31]
    v_exp_f32 v20, v20
    v_mfma_f32_16x16x32_bf16 v[28:31], a[224:227], a[164:167], v[28:31]
    v_cvt_pk_bf16_f32 v68, v16, v17
    v_cvt_pk_bf16_f32 v69, v18, v19
    v_mfma_f32_16x16x32_bf16 v[120:123], v[216:219], v[60:63], v[120:123]
    v_exp_f32 v21, v21
    v_mfma_f32_16x16x32_bf16 v[124:127], v[220:223], v[60:63], v[124:127]
    v_exp_f32 v22, v22
    v_mfma_f32_16x16x32_bf16 v[128:131], v[224:227], v[60:63], v[128:131]
    v_exp_f32 v23, v23
    s_waitcnt lgkmcnt(0)
    s_barrier
    v_mfma_f32_16x16x32_bf16 v[132:135], v[228:231], v[60:63], v[132:135]
    ds_read_b64 v[92:93], v7 offset:24576
    ds_read_b64 v[96:97], v7 offset:25600
    ds_read_b64 v[100:101], v7 offset:26624
    v_mfma_f32_16x16x32_bf16 v[136:139], v[232:235], v[60:63], v[136:139]
    v_cvt_pk_bf16_f32 v70, v20, v21
    v_cvt_pk_bf16_f32 v71, v22, v23
    v_mfma_f32_16x16x32_bf16 v[140:143], v[236:239], v[60:63], v[140:143]
    ds_read_b128 v[32:35], v7 offset:0
    ds_read_b128 v[36:39], v7 offset:1024
    ds_read_b128 v[40:43], v7 offset:2048
    v_smfmac_f32_16x16x64_bf16 a[240:243], v[84:87], v[56:63], v88
    ds_read_b128 v[44:47], v7 offset:3072
    ds_read_b128 v[48:51], v7 offset:4096
    ds_read_b128 v[52:55], v7 offset:5120
    v_mfma_f32_16x16x32_bf16 v[144:147], v[216:219], v[68:71], v[144:147]
    v_exp_f32 v24, v24
    v_exp_f32 v25, v25
    v_mfma_f32_16x16x32_bf16 v[148:151], v[220:223], v[68:71], v[148:151]
    v_exp_f32 v26, v26
    v_exp_f32 v27, v27
    v_mfma_f32_16x16x32_bf16 v[152:155], v[224:227], v[68:71], v[152:155]
    v_exp_f32 v28, v28
    v_cvt_pk_bf16_f32 v76, v24, v25
    v_mfma_f32_16x16x32_bf16 v[156:159], v[228:231], v[68:71], v[156:159]
    v_cvt_pk_bf16_f32 v77, v26, v27
    v_exp_f32 v29, v29
    v_mfma_f32_16x16x32_bf16 v[160:163], v[232:235], v[68:71], v[160:163]
    v_exp_f32 v30, v30
    v_exp_f32 v31, v31
    v_mfma_f32_16x16x32_bf16 v[164:167], v[236:239], v[68:71], v[164:167]
    v_cvt_pk_bf16_f32 v78, v28, v29
    v_cvt_pk_bf16_f32 v79, v30, v31
    v_smfmac_f32_16x16x64_bf16 a[244:247], v[84:87], v[64:71], v88
    ds_read_b128 v[192:195], v7 offset:6144
    ds_read_b128 v[196:199], v7 offset:7168
    ds_read_b128 v[200:203], v7 offset:8192
    v_mfma_f32_16x16x32_bf16 v[168:171], v[216:219], v[76:79], v[168:171]
    ds_read_b128 v[204:207], v7 offset:9216
    ds_read_b128 v[208:211], v7 offset:10240
    ds_read_b128 v[212:215], v7 offset:11264
    v_mfma_f32_16x16x32_bf16 v[172:175], v[220:223], v[76:79], v[172:175]
    s_waitcnt lgkmcnt(10)
    v_accvgpr_read_b32 v94, a240
    v_mfma_f32_16x16x32_bf16 v[176:179], v[224:227], v[76:79], v[176:179]
    v_accvgpr_read_b32 v95, a241
    v_add_f32 v92, v92, v93
    v_add_f32 v94, v94, v95
    v_mfma_f32_16x16x32_bf16 v[180:183], v[228:231], v[76:79], v[180:183]
    v_add_f32 v94, v94, v92
    v_rcp_f32 v95, v94
    v_mfma_f32_16x16x32_bf16 v[184:187], v[232:235], v[76:79], v[184:187]
    v_add_f32 v120, v120, v32
    v_add_f32 v121, v121, v33
    v_add_f32 v122, v122, v34
    v_mfma_f32_16x16x32_bf16 v[188:191], v[236:239], v[76:79], v[188:191]
    v_add_f32 v123, v123, v35
    v_add_f32 v124, v124, v36
    v_smfmac_f32_16x16x64_bf16 a[248:251], v[84:87], v[72:79], v88
    v_add_f32 v125, v125, v37
    v_add_f32 v126, v126, v38
    v_add_f32 v127, v127, v39
    s_branch L_epi
.p2align 6
L_loop1:
    v_mfma_f32_16x16x32_bf16 v[8:11], a[180:183], a[96:99], v[92:95]
    v_exp_f32 v24, v24
    v_mfma_f32_16x16x32_bf16 v[8:11], a[184:187], a[100:103], v[8:11]
    v_exp_f32 v25, v25
    v_mfma_f32_16x16x32_bf16 v[8:11], a[188:191], a[104:107], v[8:11]
    v_exp_f32 v26, v26
    v_mfma_f32_16x16x32_bf16 v[12:15], a[192:195], a[96:99], v[92:95]
    v_exp_f32 v27, v27
    v_mfma_f32_16x16x32_bf16 v[12:15], a[196:199], a[100:103], v[12:15]
    v_exp_f32 v28, v28
    v_mfma_f32_16x16x32_bf16 v[12:15], a[200:203], a[104:107], v[12:15]
    v_cvt_pk_bf16_f32 v80, v24, v25
    v_cvt_pk_bf16_f32 v81, v26, v27
    v_mfma_f32_16x16x32_bf16 v[168:171], v[216:219], v[76:79], v[168:171]
    v_exp_f32 v29, v29
    v_mfma_f32_16x16x32_bf16 v[172:175], v[220:223], v[76:79], v[172:175]
    v_exp_f32 v30, v30
    v_mfma_f32_16x16x32_bf16 v[176:179], v[224:227], v[76:79], v[176:179]
    v_exp_f32 v31, v31
    v_mfma_f32_16x16x32_bf16 v[180:183], v[228:231], v[76:79], v[180:183]
    buffer_load_dwordx4 a[212:215], v3, s[28:31], s60 offen offset:2048
    v_mfma_f32_16x16x32_bf16 v[184:187], v[232:235], v[76:79], v[184:187]
    v_cvt_pk_bf16_f32 v82, v28, v29
    v_cvt_pk_bf16_f32 v83, v30, v31
    v_mfma_f32_16x16x32_bf16 v[188:191], v[236:239], v[76:79], v[188:191]
    buffer_load_dwordx4 a[216:219], v3, s[28:31], s60 offen offset:3072
    v_smfmac_f32_16x16x64_bf16 a[248:251], v[84:87], v[72:79], v88
    v_mfma_f32_16x16x32_bf16 v[16:19], a[180:183], a[108:111], v[96:99]
    v_exp_f32 v8, v8
    v_mfma_f32_16x16x32_bf16 v[16:19], a[184:187], a[112:115], v[16:19]
    v_exp_f32 v9, v9
    v_mfma_f32_16x16x32_bf16 v[16:19], a[188:191], a[116:119], v[16:19]
    v_exp_f32 v10, v10
    v_mfma_f32_16x16x32_bf16 v[20:23], a[192:195], a[108:111], v[96:99]
    v_exp_f32 v11, v11
    v_mfma_f32_16x16x32_bf16 v[20:23], a[196:199], a[112:115], v[20:23]
    v_exp_f32 v12, v12
    v_mfma_f32_16x16x32_bf16 v[20:23], a[200:203], a[116:119], v[20:23]
    v_cvt_pk_bf16_f32 v32, v8, v9
    v_cvt_pk_bf16_f32 v33, v10, v11
    v_mfma_f32_16x16x32_bf16 a[72:75], v[216:219], v[80:83], a[72:75]
    v_exp_f32 v13, v13
    v_mfma_f32_16x16x32_bf16 a[76:79], v[220:223], v[80:83], a[76:79]
    v_exp_f32 v14, v14
    v_mfma_f32_16x16x32_bf16 a[80:83], v[224:227], v[80:83], a[80:83]
    v_exp_f32 v15, v15
    v_mfma_f32_16x16x32_bf16 a[84:87], v[228:231], v[80:83], a[84:87]
    buffer_load_dwordx4 a[220:223], v4, s[28:31], s60 offen offset:0
    v_mfma_f32_16x16x32_bf16 a[88:91], v[232:235], v[80:83], a[88:91]
    v_cvt_pk_bf16_f32 v34, v12, v13
    v_cvt_pk_bf16_f32 v35, v14, v15
    v_mfma_f32_16x16x32_bf16 a[92:95], v[236:239], v[80:83], a[92:95]
    buffer_load_dwordx4 a[224:227], v4, s[28:31], s60 offen offset:1024
    v_mfma_f32_16x16x32_bf16 a[252:255], v[84:87], v[80:83], a[252:255]
    s_waitcnt vmcnt(6)
L_s2_1:
    v_mfma_f32_16x16x32_bf16 v[8:11], a[180:183], a[120:123], v[100:103]
    v_exp_f32 v16, v16
    v_mfma_f32_16x16x32_bf16 v[8:11], a[184:187], a[124:127], v[8:11]
    v_exp_f32 v17, v17
    v_mfma_f32_16x16x32_bf16 v[8:11], a[188:191], a[128:131], v[8:11]
    v_exp_f32 v18, v18
    v_mfma_f32_16x16x32_bf16 v[12:15], a[192:195], a[120:123], v[100:103]
    v_exp_f32 v19, v19
    v_mfma_f32_16x16x32_bf16 v[12:15], a[196:199], a[124:127], v[12:15]
    v_exp_f32 v20, v20
    v_mfma_f32_16x16x32_bf16 v[12:15], a[200:203], a[128:131], v[12:15]
    v_cvt_pk_bf16_f32 v40, v16, v17
    v_cvt_pk_bf16_f32 v41, v18, v19
    v_mfma_f32_16x16x32_bf16 a[0:3], v[192:195], v[32:35], a[0:3]
    v_exp_f32 v21, v21
    v_mfma_f32_16x16x32_bf16 a[4:7], v[196:199], v[32:35], a[4:7]
    v_exp_f32 v22, v22
    v_mfma_f32_16x16x32_bf16 a[8:11], v[200:203], v[32:35], a[8:11]
    v_exp_f32 v23, v23
    v_mfma_f32_16x16x32_bf16 a[12:15], v[204:207], v[32:35], a[12:15]
    buffer_load_dwordx4 v[216:219], v4, s[28:31], s60 offen offset:2048
    v_mfma_f32_16x16x32_bf16 a[16:19], v[208:211], v[32:35], a[16:19]
    v_cvt_pk_bf16_f32 v42, v20, v21
    v_cvt_pk_bf16_f32 v43, v22, v23
    v_mfma_f32_16x16x32_bf16 a[20:23], v[212:215], v[32:35], a[20:23]
    buffer_load_dwordx4 v[220:223], v4, s[28:31], s60 offen offset:3072
    v_mfma_f32_16x16x32_bf16 v[16:19], a[180:183], a[132:135], v[104:107]
    v_exp_f32 v8, v8
    v_mfma_f32_16x16x32_bf16 v[16:19], a[184:187], a[136:139], v[16:19]
    v_exp_f32 v9, v9
    v_mfma_f32_16x16x32_bf16 v[16:19], a[188:191], a[140:143], v[16:19]
    v_exp_f32 v10, v10
    v_mfma_f32_16x16x32_bf16 v[20:23], a[192:195], a[132:135], v[104:107]
    v_exp_f32 v11, v11
    v_mfma_f32_16x16x32_bf16 v[20:23], a[196:199], a[136:139], v[20:23]
    v_exp_f32 v12, v12
    v_mfma_f32_16x16x32_bf16 v[20:23], a[200:203], a[140:143], v[20:23]
    v_cvt_pk_bf16_f32 v48, v8, v9
    v_cvt_pk_bf16_f32 v49, v10, v11
    v_mfma_f32_16x16x32_bf16 a[24:27], v[192:195], v[40:43], a[24:27]
    v_exp_f32 v13, v13
    v_mfma_f32_16x16x32_bf16 a[28:31], v[196:199], v[40:43], a[28:31]
    v_exp_f32 v14, v14
    v_mfma_f32_16x16x32_bf16 a[32:35], v[200:203], v[40:43], a[32:35]
    v_exp_f32 v15, v15
    v_mfma_f32_16x16x32_bf16 a[36:39], v[204:207], v[40:43], a[36:39]
    buffer_load_dwordx4 v[224:227], v5, s[28:31], s60 offen offset:0
    v_mfma_f32_16x16x32_bf16 a[40:43], v[208:211], v[40:43], a[40:43]
    v_cvt_pk_bf16_f32 v50, v12, v13
    v_cvt_pk_bf16_f32 v51, v14, v15
    v_mfma_f32_16x16x32_bf16 a[44:47], v[212:215], v[40:43], a[44:47]
    buffer_load_dwordx4 v[228:231], v5, s[28:31], s60 offen offset:1024
    v_mfma_f32_16x16x32_bf16 v[8:11], a[180:183], a[144:147], v[108:111]
    v_exp_f32 v16, v16
    v_mfma_f32_16x16x32_bf16 v[8:11], a[184:187], a[148:151], v[8:11]
    v_exp_f32 v17, v17
    v_mfma_f32_16x16x32_bf16 v[8:11], a[188:191], a[152:155], v[8:11]
    v_exp_f32 v18, v18
    v_mfma_f32_16x16x32_bf16 v[12:15], a[192:195], a[144:147], v[108:111]
    v_exp_f32 v19, v19
    v_mfma_f32_16x16x32_bf16 v[12:15], a[196:199], a[148:151], v[12:15]
    v_exp_f32 v20, v20
    v_mfma_f32_16x16x32_bf16 v[12:15], a[200:203], a[152:155], v[12:15]
    v_cvt_pk_bf16_f32 v56, v16, v17
    v_cvt_pk_bf16_f32 v57, v18, v19
    v_mfma_f32_16x16x32_bf16 a[48:51], v[192:195], v[48:51], a[48:51]
    v_exp_f32 v21, v21
    v_mfma_f32_16x16x32_bf16 a[52:55], v[196:199], v[48:51], a[52:55]
    v_exp_f32 v22, v22
    v_mfma_f32_16x16x32_bf16 a[56:59], v[200:203], v[48:51], a[56:59]
    v_exp_f32 v23, v23
    v_mfma_f32_16x16x32_bf16 a[60:63], v[204:207], v[48:51], a[60:63]
    buffer_load_dwordx4 v[232:235], v5, s[28:31], s60 offen offset:2048
    v_mfma_f32_16x16x32_bf16 a[64:67], v[208:211], v[48:51], a[64:67]
    v_cvt_pk_bf16_f32 v58, v20, v21
    v_cvt_pk_bf16_f32 v59, v22, v23
    v_mfma_f32_16x16x32_bf16 a[68:71], v[212:215], v[48:51], a[68:71]
    buffer_load_dwordx4 v[236:239], v5, s[28:31], s60 offen offset:3072
    s_add_u32 s60, s60, 36864
    s_waitcnt vmcnt(6)
    v_mfma_f32_16x16x32_bf16 v[16:19], a[180:183], a[156:159], v[112:115]
    v_exp_f32 v8, v8
    v_mfma_f32_16x16x32_bf16 v[16:19], a[184:187], a[160:163], v[16:19]
    v_exp_f32 v9, v9
    v_mfma_f32_16x16x32_bf16 v[16:19], a[188:191], a[164:167], v[16:19]
    v_exp_f32 v10, v10
    v_mfma_f32_16x16x32_bf16 v[20:23], a[192:195], a[156:159], v[112:115]
    v_exp_f32 v11, v11
    v_mfma_f32_16x16x32_bf16 v[20:23], a[196:199], a[160:163], v[20:23]
    v_exp_f32 v12, v12
    v_mfma_f32_16x16x32_bf16 v[20:23], a[200:203], a[164:167], v[20:23]
    v_cvt_pk_bf16_f32 v64, v8, v9
    v_cvt_pk_bf16_f32 v65, v10, v11
    v_cmp_eq_u32 vcc, 0, v89
    v_mfma_f32_16x16x32_bf16 v[120:123], v[192:195], v[56:59], v[120:123]
    v_exp_f32 v13, v13
    v_mfma_f32_16x16x32_bf16 v[124:127], v[196:199], v[56:59], v[124:127]
    v_exp_f32 v14, v14
    s_cbranch_vccnz L_slow1
L_back1:
    v_mfma_f32_16x16x32_bf16 v[128:131], v[200:203], v[56:59], v[128:131]
    v_exp_f32 v15, v15
    v_mfma_f32_16x16x32_bf16 v[132:135], v[204:207], v[56:59], v[132:135]
    buffer_load_dwordx4 a[180:183], v3, s[28:31], s60 offen offset:0
    v_mfma_f32_16x16x32_bf16 v[136:139], v[208:211], v[56:59], v[136:139]
    v_cvt_pk_bf16_f32 v66, v12, v13
    v_cvt_pk_bf16_f32 v67, v14, v15
    v_mfma_f32_16x16x32_bf16 v[140:143], v[212:215], v[56:59], v[140:143]
    buffer_load_dwordx4 a[184:187], v3, s[28:31], s60 offen offset:1024
    v_mfma_f32_16x16x32_bf16 v[8:11], a[204:207], a[96:99], v[92:95]
    v_exp_f32 v16, v16
    v_mfma_f32_16x16x32_bf16 v[8:11], a[208:211], a[100:103], v[8:11]
    v_exp_f32 v17, v17
    v_mfma_f32_16x16x32_bf16 v[8:11], a[212:215], a[104:107], v[8:11]
    v_exp_f32 v18, v18
    v_mfma_f32_16x16x32_bf16 v[12:15], a[216:219], a[96:99], v[92:95]
    v_exp_f32 v19, v19
    v_mfma_f32_16x16x32_bf16 v[12:15], a[220:223], a[100:103], v[12:15]
    v_exp_f32 v20, v20
    v_mfma_f32_16x16x32_bf16 v[12:15], a[224:227], a[104:107], v[12:15]
    v_cvt_pk_bf16_f32 v72, v16, v17
    v_cvt_pk_bf16_f32 v73, v18, v19
    v_mfma_f32_16x16x32_bf16 v[144:147], v[192:195], v[64:67], v[144:147]
    v_exp_f32 v21, v21
    v_mfma_f32_16x16x32_bf16 v[148:151], v[196:199], v[64:67], v[148:151]
    v_exp_f32 v22, v22
    v_mfma_f32_16x16x32_bf16 v[152:155], v[200:203], v[64:67], v[152:155]
    v_exp_f32 v23, v23
    v_mfma_f32_16x16x32_bf16 v[156:159], v[204:207], v[64:67], v[156:159]
    buffer_load_dwordx4 a[188:191], v3, s[28:31], s60 offen offset:2048
    v_mfma_f32_16x16x32_bf16 v[160:163], v[208:211], v[64:67], v[160:163]
    v_cvt_pk_bf16_f32 v74, v20, v21
    v_cvt_pk_bf16_f32 v75, v22, v23
    v_mfma_f32_16x16x32_bf16 v[164:167], v[212:215], v[64:67], v[164:167]
    buffer_load_dwordx4 a[192:195], v3, s[28:31], s60 offen offset:3072
    v_mfma_f32_16x16x32_bf16 v[16:19], a[204:207], a[108:111], v[96:99]
    v_exp_f32 v8, v8
    v_mfma_f32_16x16x32_bf16 v[16:19], a[208:211], a[112:115], v[16:19]
    v_exp_f32 v9, v9
    v_mfma_f32_16x16x32_bf16 v[16:19], a[212:215], a[116:119], v[16:19]
    v_exp_f32 v10, v10
    v_mfma_f32_16x16x32_bf16 v[20:23], a[216:219], a[108:111], v[96:99]
    v_exp_f32 v11, v11
    v_mfma_f32_16x16x32_bf16 v[20:23], a[220:223], a[112:115], v[20:23]
    v_exp_f32 v12, v12
    v_mfma_f32_16x16x32_bf16 v[20:23], a[224:227], a[116:119], v[20:23]
    v_cvt_pk_bf16_f32 v36, v8, v9
    v_cvt_pk_bf16_f32 v37, v10, v11
    v_mfma_f32_16x16x32_bf16 v[168:171], v[192:195], v[72:75], v[168:171]
    v_exp_f32 v13, v13
    v_mfma_f32_16x16x32_bf16 v[172:175], v[196:199], v[72:75], v[172:175]
    v_exp_f32 v14, v14
    v_mfma_f32_16x16x32_bf16 v[176:179], v[200:203], v[72:75], v[176:179]
    v_exp_f32 v15, v15
    v_mfma_f32_16x16x32_bf16 v[180:183], v[204:207], v[72:75], v[180:183]
    buffer_load_dwordx4 a[196:199], v4, s[28:31], s60 offen offset:0
    v_mfma_f32_16x16x32_bf16 v[184:187], v[208:211], v[72:75], v[184:187]
    v_cvt_pk_bf16_f32 v38, v12, v13
    v_cvt_pk_bf16_f32 v39, v14, v15
    v_mfma_f32_16x16x32_bf16 v[188:191], v[212:215], v[72:75], v[188:191]
    buffer_load_dwordx4 a[200:203], v4, s[28:31], s60 offen offset:1024
    s_waitcnt vmcnt(6)
    v_mfma_f32_16x16x32_bf16 v[8:11], a[204:207], a[120:123], v[100:103]
    v_exp_f32 v16, v16
    v_mfma_f32_16x16x32_bf16 v[8:11], a[208:211], a[124:127], v[8:11]
    v_exp_f32 v17, v17
    v_mfma_f32_16x16x32_bf16 v[8:11], a[212:215], a[128:131], v[8:11]
    v_exp_f32 v18, v18
    v_mfma_f32_16x16x32_bf16 v[12:15], a[216:219], a[120:123], v[100:103]
    v_exp_f32 v19, v19
    v_mfma_f32_16x16x32_bf16 v[12:15], a[220:223], a[124:127], v[12:15]
    v_exp_f32 v20, v20
    v_mfma_f32_16x16x32_bf16 v[12:15], a[224:227], a[128:131], v[12:15]
    v_cvt_pk_bf16_f32 v44, v16, v17
    v_cvt_pk_bf16_f32 v45, v18, v19
    v_mfma_f32_16x16x32_bf16 a[0:3], v[216:219], v[36:39], a[0:3]
    v_exp_f32 v21, v21
    v_mfma_f32_16x16x32_bf16 a[4:7], v[220:223], v[36:39], a[4:7]
    v_exp_f32 v22, v22
    v_mfma_f32_16x16x32_bf16 a[8:11], v[224:227], v[36:39], a[8:11]
    v_exp_f32 v23, v23
    v_mfma_f32_16x16x32_bf16 a[12:15], v[228:231], v[36:39], a[12:15]
    buffer_load_dwordx4 v[192:195], v4, s[28:31], s60 offen offset:2048
    v_mfma_f32_16x16x32_bf16 a[16:19], v[232:235], v[36:39], a[16:19]
    v_cvt_pk_bf16_f32 v46, v20, v21
    v_cvt_pk_bf16_f32 v47, v22, v23
    v_mfma_f32_16x16x32_bf16 a[20:23], v[236:239], v[36:39], a[20:23]
    buffer_load_dwordx4 v[196:199], v4, s[28:31], s60 offen offset:3072
    v_smfmac_f32_16x16x64_bf16 a[228:231], v[84:87], v[32:39], v88
    s_sub_u32 s61, s61, 1
    v_mfma_f32_16x16x32_bf16 v[16:19], a[204:207], a[132:135], v[104:107]
    v_exp_f32 v8, v8
    v_mfma_f32_16x16x32_bf16 v[16:19], a[208:211], a[136:139], v[16:19]
    v_exp_f32 v9, v9
    v_mfma_f32_16x16x32_bf16 v[16:19], a[212:215], a[140:143], v[16:19]
    v_exp_f32 v10, v10
    v_mfma_f32_16x16x32_bf16 v[20:23], a[216:219], a[132:135], v[104:107]
    v_exp_f32 v11, v11
    v_mfma_f32_16x16x32_bf16 v[20:23], a[220:223], a[136:139], v[20:23]
    v_exp_f32 v12, v12
    v_mfma_f32_16x16x32_bf16 v[20:23], a[224:227], a[140:143], v[20:23]
    v_cvt_pk_bf16_f32 v52, v8, v9
    v_cvt_pk_bf16_f32 v53, v10, v11
    v_mfma_f32_16x16x32_bf16 a[24:27], v[216:219], v[44:47], a[24:27]
    v_exp_f32 v13, v13
    v_mfma_f32_16x16x32_bf16 a[28:31], v[220:223], v[44:47], a[28:31]
    v_exp_f32 v14, v14
    v_mfma_f32_16x16x32_bf16 a[32:35], v[224:227], v[44:47], a[32:35]
    v_exp_f32 v15, v15
    v_mfma_f32_16x16x32_bf16 a[36:39], v[228:231], v[44:47], a[36:39]
    buffer_load_dwordx4 v[200:203], v5, s[28:31], s60 offen offset:0
    v_mfma_f32_16x16x32_bf16 a[40:43], v[232:235], v[44:47], a[40:43]
    v_cvt_pk_bf16_f32 v54, v12, v13
    v_cvt_pk_bf16_f32 v55, v14, v15
    v_mfma_f32_16x16x32_bf16 a[44:47], v[236:239], v[44:47], a[44:47]
    buffer_load_dwordx4 v[204:207], v5, s[28:31], s60 offen offset:1024
    v_smfmac_f32_16x16x64_bf16 a[232:235], v[84:87], v[40:47], v88
    s_cmp_eq_u32 s61, 6
    s_cbranch_scc1 L_fv1
L_fvb1:
    v_mfma_f32_16x16x32_bf16 v[8:11], a[204:207], a[144:147], v[108:111]
    v_exp_f32 v16, v16
    v_mfma_f32_16x16x32_bf16 v[8:11], a[208:211], a[148:151], v[8:11]
    v_exp_f32 v17, v17
    v_mfma_f32_16x16x32_bf16 v[8:11], a[212:215], a[152:155], v[8:11]
    v_exp_f32 v18, v18
    v_mfma_f32_16x16x32_bf16 v[12:15], a[216:219], a[144:147], v[108:111]
    v_exp_f32 v19, v19
    v_mfma_f32_16x16x32_bf16 v[12:15], a[220:223], a[148:151], v[12:15]
    v_exp_f32 v20, v20
    v_mfma_f32_16x16x32_bf16 v[12:15], a[224:227], a[152:155], v[12:15]
    v_cvt_pk_bf16_f32 v60, v16, v17
    v_cvt_pk_bf16_f32 v61, v18, v19
    v_mfma_f32_16x16x32_bf16 a[48:51], v[216:219], v[52:55], a[48:51]
    v_exp_f32 v21, v21
    v_mfma_f32_16x16x32_bf16 a[52:55], v[220:223], v[52:55], a[52:55]
    v_exp_f32 v22, v22
    v_mfma_f32_16x16x32_bf16 a[56:59], v[224:227], v[52:55], a[56:59]
    v_exp_f32 v23, v23
    v_mfma_f32_16x16x32_bf16 a[60:63], v[228:231], v[52:55], a[60:63]
    buffer_load_dwordx4 v[208:211], v5, s[28:31], s60 offen offset:2048
    v_mfma_f32_16x16x32_bf16 a[64:67], v[232:235], v[52:55], a[64:67]
    v_cvt_pk_bf16_f32 v62, v20, v21
    v_cvt_pk_bf16_f32 v63, v22, v23
    v_mfma_f32_16x16x32_bf16 a[68:71], v[236:239], v[52:55], a[68:71]
    buffer_load_dwordx4 v[212:215], v5, s[28:31], s60 offen offset:3072
    v_smfmac_f32_16x16x64_bf16 a[236:239], v[84:87], v[48:55], v88
    v_mfma_f32_16x16x32_bf16 v[16:19], a[204:207], a[156:159], v[112:115]
    v_exp_f32 v8, v8
    v_mfma_f32_16x16x32_bf16 v[16:19], a[208:211], a[160:163], v[16:19]
    v_exp_f32 v9, v9
    v_mfma_f32_16x16x32_bf16 v[16:19], a[212:215], a[164:167], v[16:19]
    v_exp_f32 v10, v10
    v_mfma_f32_16x16x32_bf16 v[20:23], a[216:219], a[156:159], v[112:115]
    v_exp_f32 v11, v11
    v_mfma_f32_16x16x32_bf16 v[20:23], a[220:223], a[160:163], v[20:23]
    v_exp_f32 v12, v12
    v_mfma_f32_16x16x32_bf16 v[20:23], a[224:227], a[164:167], v[20:23]
    v_cvt_pk_bf16_f32 v68, v8, v9
    v_cvt_pk_bf16_f32 v69, v10, v11
    v_mfma_f32_16x16x32_bf16 v[120:123], v[216:219], v[60:63], v[120:123]
    v_exp_f32 v13, v13
    v_mfma_f32_16x16x32_bf16 v[124:127], v[220:223], v[60:63], v[124:127]
    v_exp_f32 v14, v14
    v_mfma_f32_16x16x32_bf16 v[128:131], v[224:227], v[60:63], v[128:131]
    v_exp_f32 v15, v15
    v_mfma_f32_16x16x32_bf16 v[132:135], v[228:231], v[60:63], v[132:135]
    s_add_u32 s60, s60, 12288
    v_mfma_f32_16x16x32_bf16 v[136:139], v[232:235], v[60:63], v[136:139]
    v_cvt_pk_bf16_f32 v70, v12, v13
    v_cvt_pk_bf16_f32 v71, v14, v15
    v_mfma_f32_16x16x32_bf16 v[140:143], v[236:239], v[60:63], v[140:143]
    v_smfmac_f32_16x16x64_bf16 a[240:243], v[84:87], v[56:63], v88
    s_waitcnt vmcnt(6)
    v_mfma_f32_16x16x32_bf16 v[24:27], a[204:207], a[168:171], v[116:119]
    v_exp_f32 v16, v16
    v_mfma_f32_16x16x32_bf16 v[24:27], a[208:211], a[172:175], v[24:27]
    v_exp_f32 v17, v17
    v_mfma_f32_16x16x32_bf16 v[24:27], a[212:215], a[176:179], v[24:27]
    v_exp_f32 v18, v18
    v_mfma_f32_16x16x32_bf16 v[28:31], a[216:219], a[168:171], v[116:119]
    v_exp_f32 v19, v19
    v_mfma_f32_16x16x32_bf16 v[28:31], a[220:223], a[172:175], v[28:31]
    v_exp_f32 v20, v20
    v_mfma_f32_16x16x32_bf16 v[28:31], a[224:227], a[176:179], v[28:31]
    v_cvt_pk_bf16_f32 v76, v16, v17
    v_cvt_pk_bf16_f32 v77, v18, v19
    v_mfma_f32_16x16x32_bf16 v[144:147], v[216:219], v[68:71], v[144:147]
    v_exp_f32 v21, v21
    v_mfma_f32_16x16x32_bf16 v[148:151], v[220:223], v[68:71], v[148:151]
    v_exp_f32 v22, v22
    v_mfma_f32_16x16x32_bf16 v[152:155], v[224:227], v[68:71], v[152:155]
    v_exp_f32 v23, v23
    v_mfma_f32_16x16x32_bf16 v[156:159], v[228:231], v[68:71], v[156:159]
    buffer_load_dwordx4 a[204:207], v3, s[28:31], s60 offen offset:0
    v_mfma_f32_16x16x32_bf16 v[160:163], v[232:235], v[68:71], v[160:163]
    v_cvt_pk_bf16_f32 v78, v20, v21
    v_cvt_pk_bf16_f32 v79, v22, v23
    s_cmp_lg_u32 s61, 0
    v_mfma_f32_16x16x32_bf16 v[164:167], v[236:239], v[68:71], v[164:167]
    buffer_load_dwordx4 a[208:211], v3, s[28:31], s60 offen offset:1024
    v_smfmac_f32_16x16x64_bf16 a[244:247], v[84:87], v[64:71], v88
    s_cbranch_scc1 L_loop1
    v_mfma_f32_16x16x32_bf16 v[8:11], a[180:183], a[96:99], v[92:95]
    v_exp_f32 v24, v24
    v_mfma_f32_16x16x32_bf16 v[8:11], a[184:187], a[100:103], v[8:11]
    v_exp_f32 v25, v25
    v_mfma_f32_16x16x32_bf16 v[8:11], a[188:191], a[104:107], v[8:11]
    v_exp_f32 v26, v26
    v_mfma_f32_16x16x32_bf16 v[12:15], a[192:195], a[96:99], v[92:95]
    v_exp_f32 v27, v27
    v_mfma_f32_16x16x32_bf16 v[12:15], a[196:199], a[100:103], v[12:15]
    v_exp_f32 v28, v28
    v_mfma_f32_16x16x32_bf16 v[12:15], a[200:203], a[104:107], v[12:15]
    v_cvt_pk_bf16_f32 v80, v24, v25
    v_cvt_pk_bf16_f32 v81, v26, v27
    v_mfma_f32_16x16x32_bf16 v[168:171], v[216:219], v[76:79], v[168:171]
    v_exp_f32 v29, v29
    v_mfma_f32_16x16x32_bf16 v[172:175], v[220:223], v[76:79], v[172:175]
    v_exp_f32 v30, v30
    v_mfma_f32_16x16x32_bf16 v[176:179], v[224:227], v[76:79], v[176:179]
    v_exp_f32 v31, v31
    v_mfma_f32_16x16x32_bf16 v[180:183], v[228:231], v[76:79], v[180:183]
    buffer_load_dwordx4 a[212:215], v3, s[28:31], s60 offen offset:2048
    v_mfma_f32_16x16x32_bf16 v[184:187], v[232:235], v[76:79], v[184:187]
    v_cvt_pk_bf16_f32 v82, v28, v29
    v_cvt_pk_bf16_f32 v83, v30, v31
    v_mfma_f32_16x16x32_bf16 v[188:191], v[236:239], v[76:79], v[188:191]
    buffer_load_dwordx4 a[216:219], v3, s[28:31], s60 offen offset:3072
    v_smfmac_f32_16x16x64_bf16 a[248:251], v[84:87], v[72:79], v88
    v_mfma_f32_16x16x32_bf16 v[16:19], a[180:183], a[108:111], v[96:99]
    v_exp_f32 v8, v8
    v_mfma_f32_16x16x32_bf16 v[16:19], a[184:187], a[112:115], v[16:19]
    v_exp_f32 v9, v9
    v_mfma_f32_16x16x32_bf16 v[16:19], a[188:191], a[116:119], v[16:19]
    v_exp_f32 v10, v10
    v_mfma_f32_16x16x32_bf16 v[20:23], a[192:195], a[108:111], v[96:99]
    v_exp_f32 v11, v11
    v_mfma_f32_16x16x32_bf16 v[20:23], a[196:199], a[112:115], v[20:23]
    v_exp_f32 v12, v12
    v_mfma_f32_16x16x32_bf16 v[20:23], a[200:203], a[116:119], v[20:23]
    v_cvt_pk_bf16_f32 v32, v8, v9
    v_cvt_pk_bf16_f32 v33, v10, v11
    v_mfma_f32_16x16x32_bf16 a[72:75], v[216:219], v[80:83], a[72:75]
    v_exp_f32 v13, v13
    v_mfma_f32_16x16x32_bf16 a[76:79], v[220:223], v[80:83], a[76:79]
    v_exp_f32 v14, v14
    v_mfma_f32_16x16x32_bf16 a[80:83], v[224:227], v[80:83], a[80:83]
    v_exp_f32 v15, v15
    v_mfma_f32_16x16x32_bf16 a[84:87], v[228:231], v[80:83], a[84:87]
    buffer_load_dwordx4 a[220:223], v4, s[28:31], s60 offen offset:0
    v_mfma_f32_16x16x32_bf16 a[88:91], v[232:235], v[80:83], a[88:91]
    v_cvt_pk_bf16_f32 v34, v12, v13
    v_cvt_pk_bf16_f32 v35, v14, v15
    v_mfma_f32_16x16x32_bf16 a[92:95], v[236:239], v[80:83], a[92:95]
    buffer_load_dwordx4 a[224:227], v4, s[28:31], s60 offen offset:1024
    v_mfma_f32_16x16x32_bf16 a[252:255], v[84:87], v[80:83], a[252:255]
    s_waitcnt vmcnt(6)
    v_mfma_f32_16x16x32_bf16 v[8:11], a[180:183], a[120:123], v[100:103]
    v_exp_f32 v16, v16
    v_mfma_f32_16x16x32_bf16 v[8:11], a[184:187], a[124:127], v[8:11]
    v_exp_f32 v17, v17
    v_mfma_f32_16x16x32_bf16 v[8:11], a[188:191], a[128:131], v[8:11]
    v_exp_f32 v18, v18
    v_mfma_f32_16x16x32_bf16 v[12:15], a[192:195], a[120:123], v[100:103]
    v_exp_f32 v19, v19
    v_mfma_f32_16x16x32_bf16 v[12:15], a[196:199], a[124:127], v[12:15]
    v_exp_f32 v20, v20
    v_mfma_f32_16x16x32_bf16 v[12:15], a[200:203], a[128:131], v[12:15]
    v_cvt_pk_bf16_f32 v40, v16, v17
    v_cvt_pk_bf16_f32 v41, v18, v19
    v_mfma_f32_16x16x32_bf16 a[0:3], v[192:195], v[32:35], a[0:3]
    v_exp_f32 v21, v21
    v_mfma_f32_16x16x32_bf16 a[4:7], v[196:199], v[32:35], a[4:7]
    v_exp_f32 v22, v22
    buffer_load_dwordx4 v[216:219], v4, s[28:31], s60 offen offset:2048
    v_mfma_f32_16x16x32_bf16 a[8:11], v[200:203], v[32:35], a[8:11]
    v_exp_f32 v23, v23
    v_mfma_f32_16x16x32_bf16 a[12:15], v[204:207], v[32:35], a[12:15]
    buffer_load_dwordx4 v[220:223], v4, s[28:31], s60 offen offset:3072
    v_mfma_f32_16x16x32_bf16 a[16:19], v[208:211], v[32:35], a[16:19]
    v_cvt_pk_bf16_f32 v42, v20, v21
    v_cvt_pk_bf16_f32 v43, v22, v23
    v_mfma_f32_16x16x32_bf16 a[20:23], v[212:215], v[32:35], a[20:23]
    buffer_load_dwordx4 v[224:227], v5, s[28:31], s60 offen offset:0
    v_mfma_f32_16x16x32_bf16 v[16:19], a[180:183], a[132:135], v[104:107]
    v_exp_f32 v8, v8
    v_mfma_f32_16x16x32_bf16 v[16:19], a[184:187], a[136:139], v[16:19]
    v_exp_f32 v9, v9
    v_mfma_f32_16x16x32_bf16 v[16:19], a[188:191], a[140:143], v[16:19]
    v_exp_f32 v10, v10
    v_mfma_f32_16x16x32_bf16 v[20:23], a[192:195], a[132:135], v[104:107]
    v_exp_f32 v11, v11
    v_mfma_f32_16x16x32_bf16 v[20:23], a[196:199], a[136:139], v[20:23]
    v_exp_f32 v12, v12
    v_mfma_f32_16x16x32_bf16 v[20:23], a[200:203], a[140:143], v[20:23]
    v_cvt_pk_bf16_f32 v48, v8, v9
    v_cvt_pk_bf16_f32 v49, v10, v11
    v_mfma_f32_16x16x32_bf16 a[24:27], v[192:195], v[40:43], a[24:27]
    v_exp_f32 v13, v13
    v_mfma_f32_16x16x32_bf16 a[28:31], v[196:199], v[40:43], a[28:31]
    v_exp_f32 v14, v14
    buffer_load_dwordx4 v[228:231], v5, s[28:31], s60 offen offset:1024
    v_mfma_f32_16x16x32_bf16 a[32:35], v[200:203], v[40:43], a[32:35]
    v_exp_f32 v15, v15
    v_mfma_f32_16x16x32_bf16 a[36:39], v[204:207], v[40:43], a[36:39]
    buffer_load_dwordx4 v[232:235], v5, s[28:31], s60 offen offset:2048
    v_mfma_f32_16x16x32_bf16 a[40:43], v[208:211], v[40:43], a[40:43]
    v_cvt_pk_bf16_f32 v50, v12, v13
    v_cvt_pk_bf16_f32 v51, v14, v15
    v_mfma_f32_16x16x32_bf16 a[44:47], v[212:215], v[40:43], a[44:47]
    buffer_load_dwordx4 v[236:239], v5, s[28:31], s60 offen offset:3072
    s_waitcnt vmcnt(6)
    v_mfma_f32_16x16x32_bf16 v[8:11], a[204:207], a[96:99], v[92:95]
    v_exp_f32 v16, v16
    v_mfma_f32_16x16x32_bf16 v[8:11], a[208:211], a[100:103], v[8:11]
    v_exp_f32 v17, v17
    v_mfma_f32_16x16x32_bf16 v[8:11], a[212:215], a[104:107], v[8:11]
    v_exp_f32 v18, v18
    v_mfma_f32_16x16x32_bf16 v[12:15], a[216:219], a[96:99], v[92:95]
    v_exp_f32 v19, v19
    v_mfma_f32_16x16x32_bf16 v[12:15], a[220:223], a[100:103], v[12:15]
    v_exp_f32 v20, v20
    v_mfma_f32_16x16x32_bf16 v[12:15], a[224:227], a[104:107], v[12:15]
    v_cvt_pk_bf16_f32 v56, v16, v17
    v_cvt_pk_bf16_f32 v57, v18, v19
    v_mfma_f32_16x16x32_bf16 a[48:51], v[192:195], v[48:51], a[48:51]
    v_exp_f32 v21, v21
    v_mfma_f32_16x16x32_bf16 a[52:55], v[196:199], v[48:51], a[52:55]
    v_exp_f32 v22, v22
    v_mfma_f32_16x16x32_bf16 a[56:59], v[200:203], v[48:51], a[56:59]
    v_exp_f32 v23, v23
    v_mfma_f32_16x16x32_bf16 a[60:63], v[204:207], v[48:51], a[60:63]
    v_mfma_f32_16x16x32_bf16 a[64:67], v[208:211], v[48:51], a[64:67]
    v_cvt_pk_bf16_f32 v58, v20, v21
    v_cvt_pk_bf16_f32 v59, v22, v23
    v_mfma_f32_16x16x32_bf16 a[68:71], v[212:215], v[48:51], a[68:71]
    v_mfma_f32_16x16x32_bf16 v[16:19], a[204:207], a[108:111], v[96:99]
    v_exp_f32 v8, v8
    v_mfma_f32_16x16x32_bf16 v[16:19], a[208:211], a[112:115], v[16:19]
    v_exp_f32 v9, v9
    v_mfma_f32_16x16x32_bf16 v[16:19], a[212:215], a[116:119], v[16:19]
    v_exp_f32 v10, v10
    v_mfma_f32_16x16x32_bf16 v[20:23], a[216:219], a[108:111], v[96:99]
    v_exp_f32 v11, v11
    v_mfma_f32_16x16x32_bf16 v[20:23], a[220:223], a[112:115], v[20:23]
    v_exp_f32 v12, v12
    v_mfma_f32_16x16x32_bf16 v[20:23], a[224:227], a[116:119], v[20:23]
    v_cvt_pk_bf16_f32 v36, v8, v9
    v_cvt_pk_bf16_f32 v37, v10, v11
    v_mfma_f32_16x16x32_bf16 v[120:123], v[192:195], v[56:59], v[120:123]
    v_exp_f32 v13, v13
    v_mfma_f32_16x16x32_bf16 v[124:127], v[196:199], v[56:59], v[124:127]
    v_exp_f32 v14, v14
    v_mfma_f32_16x16x32_bf16 v[128:131], v[200:203], v[56:59], v[128:131]
    v_exp_f32 v15, v15
    v_mfma_f32_16x16x32_bf16 v[132:135], v[204:207], v[56:59], v[132:135]
    v_mfma_f32_16x16x32_bf16 v[136:139], v[208:211], v[56:59], v[136:139]
    v_cvt_pk_bf16_f32 v38, v12, v13
    v_cvt_pk_bf16_f32 v39, v14, v15
    v_mfma_f32_16x16x32_bf16 v[140:143], v[212:215], v[56:59], v[140:143]
    v_mfma_f32_16x16x32_bf16 v[8:11], a[204:207], a[120:123], v[100:103]
    v_exp_f32 v16, v16
    v_mfma_f32_16x16x32_bf16 v[8:11], a[208:211], a[124:127], v[8:11]
    v_exp_f32 v17, v17
    v_mfma_f32_16x16x32_bf16 v[8:11], a[212:215], a[128:131], v[8:11]
    v_exp_f32 v18, v18
    v_mfma_f32_16x16x32_bf16 v[12:15], a[216:219], a[120:123], v[100:103]
    v_exp_f32 v19, v19
    v_mfma_f32_16x16x32_bf16 v[12:15], a[220:223], a[124:127], v[12:15]
    v_exp_f32 v20, v20
    v_mfma_f32_16x16x32_bf16 v[12:15], a[224:227], a[128:131], v[12:15]
    v_cvt_pk_bf16_f32 v44, v16, v17
    v_cvt_pk_bf16_f32 v45, v18, v19
    s_waitcnt vmcnt(0)
    v_mfma_f32_16x16x32_bf16 a[0:3], v[216:219], v[36:39], a[0:3]
    v_exp_f32 v21, v21
    v_mfma_f32_16x16x32_bf16 a[4:7], v[220:223], v[36:39], a[4:7]
    v_exp_f32 v22, v22
    v_mfma_f32_16x16x32_bf16 a[8:11], v[224:227], v[36:39], a[8:11]
    v_exp_f32 v23, v23
    v_mfma_f32_16x16x32_bf16 a[12:15], v[228:231], v[36:39], a[12:15]
    v_mfma_f32_16x16x32_bf16 a[16:19], v[232:235], v[36:39], a[16:19]
    v_cvt_pk_bf16_f32 v46, v20, v21
    v_cvt_pk_bf16_f32 v47, v22, v23
    v_mfma_f32_16x16x32_bf16 a[20:23], v[236:239], v[36:39], a[20:23]
    ds_write_b128 v6, a[0:3] offset:0
    v_smfmac_f32_16x16x64_bf16 a[228:231], v[84:87], v[32:39], v88
    ds_write_b128 v6, a[4:7] offset:1024
    v_mfma_f32_16x16x32_bf16 v[16:19], a[204:207], a[168:171], v[116:119]
    v_exp_f32 v8, v8
    v_mfma_f32_16x16x32_bf16 v[16:19], a[208:211], a[172:175], v[16:19]
    v_exp_f32 v9, v9
    v_mfma_f32_16x16x32_bf16 v[16:19], a[212:215], a[176:179], v[16:19]
    v_exp_f32 v10, v10
    ds_write_b128 v6, a[8:11] offset:2048
    v_mfma_f32_16x16x32_bf16 v[20:23], a[216:219], a[168:171], v[116:119]
    v_exp_f32 v11, v11
    v_mfma_f32_16x16x32_bf16 v[20:23], a[220:223], a[172:175], v[20:23]
    v_exp_f32 v12, v12
    v_mfma_f32_16x16x32_bf16 v[20:23], a[224:227], a[176:179], v[20:23]
    v_cvt_pk_bf16_f32 v52, v8, v9
    v_cvt_pk_bf16_f32 v53, v10, v11
    ds_write_b128 v6, a[12:15] offset:3072
    v_mfma_f32_16x16x32_bf16 a[24:27], v[216:219], v[44:47], a[24:27]
    v_exp_f32 v13, v13
    v_mfma_f32_16x16x32_bf16 a[28:31], v[220:223], v[44:47], a[28:31]
    v_exp_f32 v14, v14
    v_mfma_f32_16x16x32_bf16 a[32:35], v[224:227], v[44:47], a[32:35]
    v_exp_f32 v15, v15
    v_mfma_f32_16x16x32_bf16 a[36:39], v[228:231], v[44:47], a[36:39]
    ds_write_b128 v6, a[16:19] offset:4096
    v_mfma_f32_16x16x32_bf16 a[40:43], v[232:235], v[44:47], a[40:43]
    v_cvt_pk_bf16_f32 v54, v12, v13
    v_cvt_pk_bf16_f32 v55, v14, v15
    v_mfma_f32_16x16x32_bf16 a[44:47], v[236:239], v[44:47], a[44:47]
    ds_write_b128 v6, a[20:23] offset:5120
    ds_write_b64 v6, a[228:229] offset:24576
    v_smfmac_f32_16x16x64_bf16 a[232:235], v[84:87], v[40:47], v88
    ds_write_b128 v6, a[24:27] offset:6144
    v_mfma_f32_16x16x32_bf16 v[8:11], a[180:183], a[144:147], v[108:111]
    v_exp_f32 v16, v16
    v_mfma_f32_16x16x32_bf16 v[8:11], a[184:187], a[148:151], v[8:11]
    v_exp_f32 v17, v17
    v_mfma_f32_16x16x32_bf16 v[8:11], a[188:191], a[152:155], v[8:11]
    v_exp_f32 v18, v18
    ds_write_b128 v6, a[28:31] offset:7168
    v_mfma_f32_16x16x32_bf16 v[12:15], a[192:195], a[144:147], v[108:111]
    v_exp_f32 v19, v19
    v_mfma_f32_16x16x32_bf16 v[12:15], a[196:199], a[148:151], v[12:15]
    v_exp_f32 v20, v20
    v_mfma_f32_16x16x32_bf16 v[12:15], a[200:203], a[152:155], v[12:15]
    v_cvt_pk_bf16_f32 v80, v16, v17
    v_cvt_pk_bf16_f32 v81, v18, v19
    ds_write_b128 v6, a[32:35] offset:8192
    v_mfma_f32_16x16x32_bf16 a[48:51], v[216:219], v[52:55], a[48:51]
    v_exp_f32 v21, v21
    v_mfma_f32_16x16x32_bf16 a[52:55], v[220:223], v[52:55], a[52:55]
    v_exp_f32 v22, v22
    v_mfma_f32_16x16x32_bf16 a[56:59], v[224:227], v[52:55], a[56:59]
    v_exp_f32 v23, v23
    v_mfma_f32_16x16x32_bf16 a[60:63], v[228:231], v[52:55], a[60:63]
    ds_write_b128 v6, a[36:39] offset:9216
    v_mfma_f32_16x16x32_bf16 a[64:67], v[232:235], v[52:55], a[64:67]
    v_cvt_pk_bf16_f32 v82, v20, v21
    v_cvt_pk_bf16_f32 v83, v22, v23
    v_mfma_f32_16x16x32_bf16 a[68:71], v[236:239], v[52:55], a[68:71]
    ds_write_b128 v6, a[40:43] offset:10240
    v_smfmac_f32_16x16x64_bf16 a[236:239], v[84:87], v[48:55], v88
    ds_write_b128 v6, a[44:47] offset:11264
    ds_write_b64 v6, a[232:233] offset:25600
    v_mfma_f32_16x16x32_bf16 v[16:19], a[180:183], a[156:159], v[112:115]
    v_exp_f32 v8, v8
    v_mfma_f32_16x16x32_bf16 v[16:19], a[184:187], a[160:163], v[16:19]
    v_exp_f32 v9, v9
    v_mfma_f32_16x16x32_bf16 v[16:19], a[188:191], a[164:167], v[16:19]
    v_exp_f32 v10, v10
    ds_write_b128 v6, a[48:51] offset:12288
    v_mfma_f32_16x16x32_bf16 v[20:23], a[192:195], a[156:159], v[112:115]
    v_exp_f32 v11, v11
    v_mfma_f32_16x16x32_bf16 v[20:23], a[196:199], a[160:163], v[20:23]
    v_exp_f32 v12, v12
    v_mfma_f32_16x16x32_bf16 v[20:23], a[200:203], a[164:167], v[20:23]
    v_cvt_pk_bf16_f32 v64, v8, v9
    v_cvt_pk_bf16_f32 v65, v10, v11
    ds_write_b128 v6, a[52:55] offset:13312
    v_mfma_f32_16x16x32_bf16 a[72:75], v[216:219], v[80:83], a[72:75]
    v_exp_f32 v13, v13
    v_mfma_f32_16x16x32_bf16 a[76:79], v[220:223], v[80:83], a[76:79]
    v_exp_f32 v14, v14
    v_mfma_f32_16x16x32_bf16 a[80:83], v[224:227], v[80:83], a[80:83]
    v_exp_f32 v15, v15
    v_mfma_f32_16x16x32_bf16 a[84:87], v[228:231], v[80:83], a[84:87]
    ds_write_b128 v6, a[56:59] offset:14336
    v_mfma_f32_16x16x32_bf16 a[88:91], v[232:235], v[80:83], a[88:91]
    v_cvt_pk_bf16_f32 v66, v12, v13
    v_cvt_pk_bf16_f32 v67, v14, v15
    v_mfma_f32_16x16x32_bf16 a[92:95], v[236:239], v[80:83], a[92:95]
    ds_write_b128 v6, a[60:63] offset:15360
    v_mfma_f32_16x16x32_bf16 a[252:255], v[84:87], v[80:83], a[252:255]
    ds_write_b128 v6, a[64:67] offset:16384
    v_mfma_f32_16x16x32_bf16 v[8:11], a[204:207], a[132:135], v[104:107]
    v_exp_f32 v16, v16
    v_mfma_f32_16x16x32_bf16 v[8:11], a[208:211], a[136:139], v[8:11]
    v_exp_f32 v17, v17
    v_mfma_f32_16x16x32_bf16 v[8:11], a[212:215], a[140:143], v[8:11]
    v_exp_f32 v18, v18
    ds_write_b128 v6, a[68:71] offset:17408
    ds_write_b64 v6, a[236:237] offset:26624
    v_mfma_f32_16x16x32_bf16 v[12:15], a[216:219], a[132:135], v[104:107]
    v_exp_f32 v19, v19
    v_mfma_f32_16x16x32_bf16 v[12:15], a[220:223], a[136:139], v[12:15]
    v_exp_f32 v20, v20
    v_mfma_f32_16x16x32_bf16 v[12:15], a[224:227], a[140:143], v[12:15]
    v_cvt_pk_bf16_f32 v72, v16, v17
    v_cvt_pk_bf16_f32 v73, v18, v19
    ds_write_b128 v6, a[72:75] offset:18432
    v_mfma_f32_16x16x32_bf16 v[144:147], v[192:195], v[64:67], v[144:147]
    v_exp_f32 v21, v21
    v_mfma_f32_16x16x32_bf16 v[148:151], v[196:199], v[64:67], v[148:151]
    v_exp_f32 v22, v22
    v_mfma_f32_16x16x32_bf16 v[152:155], v[200:203], v[64:67], v[152:155]
    v_exp_f32 v23, v23
    v_mfma_f32_16x16x32_bf16 v[156:159], v[204:207], v[64:67], v[156:159]
    ds_write_b128 v6, a[76:79] offset:19456
    v_mfma_f32_16x16x32_bf16 v[160:163], v[208:211], v[64:67], v[160:163]
    v_cvt_pk_bf16_f32 v74, v20, v21
    v_cvt_pk_bf16_f32 v75, v22, v23
    v_mfma_f32_16x16x32_bf16 v[164:167], v[212:215], v[64:67], v[164:167]
    ds_write_b128 v6, a[80:83] offset:20480
    v_mfma_f32_16x16x32_bf16 v[16:19], a[204:207], a[144:147], v[108:111]
    v_exp_f32 v8, v8
    v_mfma_f32_16x16x32_bf16 v[16:19], a[208:211], a[148:151], v[16:19]
    v_exp_f32 v9, v9
    v_mfma_f32_16x16x32_bf16 v[16:19], a[212:215], a[152:155], v[16:19]
    v_exp_f32 v10, v10
    ds_write_b128 v6, a[84:87] offset:21504
    v_mfma_f32_16x16x32_bf16 v[20:23], a[216:219], a[144:147], v[108:111]
    v_exp_f32 v11, v11
    v_mfma_f32_16x16x32_bf16 v[20:23], a[220:223], a[148:151], v[20:23]
    v_exp_f32 v12, v12
    v_mfma_f32_16x16x32_bf16 v[20:23], a[224:227], a[152:155], v[20:23]
    v_cvt_pk_bf16_f32 v60, v8, v9
    v_cvt_pk_bf16_f32 v61, v10, v11
    ds_write_b128 v6, a[88:91] offset:22528
    v_mfma_f32_16x16x32_bf16 v[168:171], v[192:195], v[72:75], v[168:171]
    v_exp_f32 v13, v13
    v_mfma_f32_16x16x32_bf16 v[172:175], v[196:199], v[72:75], v[172:175]
    v_exp_f32 v14, v14
    v_mfma_f32_16x16x32_bf16 v[176:179], v[200:203], v[72:75], v[176:179]
    v_exp_f32 v15, v15
    v_mfma_f32_16x16x32_bf16 v[180:183], v[204:207], v[72:75], v[180:183]
    ds_write_b128 v6, a[92:95] offset:23552
    ds_write_b32 v6, a252 offset:27648
    v_mfma_f32_16x16x32_bf16 v[184:187], v[208:211], v[72:75], v[184:187]
    v_cvt_pk_bf16_f32 v62, v12, v13
    v_cvt_pk_bf16_f32 v63, v14, v15
    v_mfma_f32_16x16x32_bf16 v[188:191], v[212:215], v[72:75], v[188:191]
    v_mfma_f32_16x16x32_bf16 v[24:27], a[204:207], a[156:159], v[112:115]
    v_exp_f32 v16, v16
    v_mfma_f32_16x16x32_bf16 v[24:27], a[208:211], a[160:163], v[24:27]
    v_exp_f32 v17, v17
    v_mfma_f32_16x16x32_bf16 v[24:27], a[212:215], a[164:167], v[24:27]
    v_exp_f32 v18, v18
    v_mfma_f32_16x16x32_bf16 v[28:31], a[216:219], a[156:159], v[112:115]
    v_exp_f32 v19, v19
    v_mfma_f32_16x16x32_bf16 v[28:31], a[220:223], a[160:163], v[28:31]
    v_exp_f32 v20, v20
    v_mfma_f32_16x16x32_bf16 v[28:31], a[224:227], a[164:167], v[28:31]
    v_cvt_pk_bf16_f32 v68, v16, v17
    v_cvt_pk_bf16_f32 v69, v18, v19
    v_mfma_f32_16x16x32_bf16 v[120:123], v[216:219], v[60:63], v[120:123]
    v_exp_f32 v21, v21
    v_mfma_f32_16x16x32_bf16 v[124:127], v[220:223], v[60:63], v[124:127]
    v_exp_f32 v22, v22
    v_mfma_f32_16x16x32_bf16 v[128:131], v[224:227], v[60:63], v[128:131]
    v_exp_f32 v23, v23
    s_waitcnt lgkmcnt(0)
    s_barrier
    v_mfma_f32_16x16x32_bf16 v[132:135], v[228:231], v[60:63], v[132:135]
    ds_read_b64 v[92:93], v7 offset:24576
    ds_read_b64 v[96:97], v7 offset:25600
    ds_read_b64 v[100:101], v7 offset:26624
    v_mfma_f32_16x16x32_bf16 v[136:139], v[232:235], v[60:63], v[136:139]
    v_cvt_pk_bf16_f32 v70, v20, v21
    v_cvt_pk_bf16_f32 v71, v22, v23
    v_mfma_f32_16x16x32_bf16 v[140:143], v[236:239], v[60:63], v[140:143]
    ds_read_b128 v[32:35], v7 offset:0
    ds_read_b128 v[36:39], v7 offset:1024
    ds_read_b128 v[40:43], v7 offset:2048
    v_smfmac_f32_16x16x64_bf16 a[240:243], v[84:87], v[56:63], v88
    ds_read_b128 v[44:47], v7 offset:3072
    ds_read_b128 v[48:51], v7 offset:4096
    ds_read_b128 v[52:55], v7 offset:5120
    v_mfma_f32_16x16x32_bf16 v[144:147], v[216:219], v[68:71], v[144:147]
    v_exp_f32 v24, v24
    v_exp_f32 v25, v25
    v_mfma_f32_16x16x32_bf16 v[148:151], v[220:223], v[68:71], v[148:151]
    v_exp_f32 v26, v26
    v_exp_f32 v27, v27
    v_mfma_f32_16x16x32_bf16 v[152:155], v[224:227], v[68:71], v[152:155]
    v_exp_f32 v28, v28
    v_cvt_pk_bf16_f32 v76, v24, v25
    v_mfma_f32_16x16x32_bf16 v[156:159], v[228:231], v[68:71], v[156:159]
    v_cvt_pk_bf16_f32 v77, v26, v27
    v_exp_f32 v29, v29
    v_mfma_f32_16x16x32_bf16 v[160:163], v[232:235], v[68:71], v[160:163]
    v_exp_f32 v30, v30
    v_exp_f32 v31, v31
    v_mfma_f32_16x16x32_bf16 v[164:167], v[236:239], v[68:71], v[164:167]
    v_cvt_pk_bf16_f32 v78, v28, v29
    v_cvt_pk_bf16_f32 v79, v30, v31
    v_smfmac_f32_16x16x64_bf16 a[244:247], v[84:87], v[64:71], v88
    ds_read_b128 v[192:195], v7 offset:6144
    ds_read_b128 v[196:199], v7 offset:7168
    ds_read_b128 v[200:203], v7 offset:8192
    v_mfma_f32_16x16x32_bf16 v[168:171], v[216:219], v[76:79], v[168:171]
    ds_read_b128 v[204:207], v7 offset:9216
    ds_read_b128 v[208:211], v7 offset:10240
    ds_read_b128 v[212:215], v7 offset:11264
    v_mfma_f32_16x16x32_bf16 v[172:175], v[220:223], v[76:79], v[172:175]
    s_waitcnt lgkmcnt(10)
    v_accvgpr_read_b32 v94, a240
    v_mfma_f32_16x16x32_bf16 v[176:179], v[224:227], v[76:79], v[176:179]
    v_accvgpr_read_b32 v95, a241
    v_add_f32 v92, v92, v93
    v_add_f32 v94, v94, v95
    v_mfma_f32_16x16x32_bf16 v[180:183], v[228:231], v[76:79], v[180:183]
    v_add_f32 v94, v94, v92
    v_rcp_f32 v95, v94
    v_mfma_f32_16x16x32_bf16 v[184:187], v[232:235], v[76:79], v[184:187]
    v_add_f32 v120, v120, v32
    v_add_f32 v121, v121, v33
    v_add_f32 v122, v122, v34
    v_mfma_f32_16x16x32_bf16 v[188:191], v[236:239], v[76:79], v[188:191]
    v_add_f32 v123, v123, v35
    v_add_f32 v124, v124, v36
    v_smfmac_f32_16x16x64_bf16 a[248:251], v[84:87], v[72:79], v88
    v_add_f32 v125, v125, v37
    v_add_f32 v126, v126, v38
    v_add_f32 v127, v127, v39
    s_branch L_epi
.p2align 6
L_loop2:
    v_mfma_f32_16x16x32_bf16 v[8:11], a[180:183], a[96:99], v[92:95]
    v_exp_f32 v16, v16
    v_mfma_f32_16x16x32_bf16 v[8:11], a[184:187], a[100:103], v[8:11]
    v_exp_f32 v17, v17
    v_mfma_f32_16x16x32_bf16 v[8:11], a[188:191], a[104:107], v[8:11]
    v_exp_f32 v18, v18
    v_mfma_f32_16x16x32_bf16 v[12:15], a[192:195], a[96:99], v[92:95]
    v_exp_f32 v19, v19
    v_mfma_f32_16x16x32_bf16 v[12:15], a[196:199], a[100:103], v[12:15]
    v_exp_f32 v20, v20
    v_mfma_f32_16x16x32_bf16 v[12:15], a[200:203], a[104:107], v[12:15]
    v_cvt_pk_bf16_f32 v76, v16, v17
    v_cvt_pk_bf16_f32 v77, v18, v19
    v_mfma_f32_16x16x32_bf16 v[144:147], v[216:219], v[68:71], v[144:147]
    v_exp_f32 v21, v21
    v_mfma_f32_16x16x32_bf16 v[148:151], v[220:223], v[68:71], v[148:151]
    v_exp_f32 v22, v22
    v_mfma_f32_16x16x32_bf16 v[152:155], v[224:227], v[68:71], v[152:155]
    v_exp_f32 v23, v23
    v_mfma_f32_16x16x32_bf16 v[156:159], v[228:231], v[68:71], v[156:159]
    buffer_load_dwordx4 a[212:215], v3, s[28:31], s60 offen offset:2048
    v_mfma_f32_16x16x32_bf16 v[160:163], v[232:235], v[68:71], v[160:163]
    v_cvt_pk_bf16_f32 v78, v20, v21
    v_cvt_pk_bf16_f32 v79, v22, v23
    v_mfma_f32_16x16x32_bf16 v[164:167], v[236:239], v[68:71], v[164:167]
    buffer_load_dwordx4 a[216:219], v3, s[28:31], s60 offen offset:3072
    v_smfmac_f32_16x16x64_bf16 a[244:247], v[84:87], v[64:71], v88
    v_mfma_f32_16x16x32_bf16 v[16:19], a[180:183], a[108:111], v[96:99]
    v_exp_f32 v8, v8
    v_mfma_f32_16x16x32_bf16 v[16:19], a[184:187], a[112:115], v[16:19]
    v_exp_f32 v9, v9
    v_mfma_f32_16x16x32_bf16 v[16:19], a[188:191], a[116:119], v[16:19]
    v_exp_f32 v10, v10
    v_mfma_f32_16x16x32_bf16 v[20:23], a[192:195], a[108:111], v[96:99]
    v_exp_f32 v11, v11
    v_mfma_f32_16x16x32_bf16 v[20:23], a[196:199], a[112:115], v[20:23]
    v_exp_f32 v12, v12
    v_mfma_f32_16x16x32_bf16 v[20:23], a[200:203], a[116:119], v[20:23]
    v_cvt_pk_bf16_f32 v32, v8, v9
    v_cvt_pk_bf16_f32 v33, v10, v11
    v_mfma_f32_16x16x32_bf16 v[168:171], v[216:219], v[76:79], v[168:171]
    v_exp_f32 v13, v13
    v_mfma_f32_16x16x32_bf16 v[172:175], v[220:223], v[76:79], v[172:175]
    v_exp_f32 v14, v14
    v_mfma_f32_16x16x32_bf16 v[176:179], v[224:227], v[76:79], v[176:179]
    v_exp_f32 v15, v15
    v_mfma_f32_16x16x32_bf16 v[180:183], v[228:231], v[76:79], v[180:183]
    buffer_load_dwordx4 a[220:223], v4, s[28:31], s60 offen offset:0
    v_mfma_f32_16x16x32_bf16 v[184:187], v[232:235], v[76:79], v[184:187]
    v_cvt_pk_bf16_f32 v34, v12, v13
    v_cvt_pk_bf16_f32 v35, v14, v15
    v_mfma_f32_16x16x32_bf16 v[188:191], v[236:239], v[76:79], v[188:191]
    buffer_load_dwordx4 a[224:227], v4, s[28:31], s60 offen offset:1024
    v_smfmac_f32_16x16x64_bf16 a[248:251], v[84:87], v[72:79], v88
    s_waitcnt vmcnt(6)
L_s2_2:
    v_mfma_f32_16x16x32_bf16 v[8:11], a[180:183], a[120:123], v[100:103]
    v_exp_f32 v16, v16
    v_mfma_f32_16x16x32_bf16 v[8:11], a[184:187], a[124:127], v[8:11]
    v_exp_f32 v17, v17
    v_mfma_f32_16x16x32_bf16 v[8:11], a[188:191], a[128:131], v[8:11]
    v_exp_f32 v18, v18
    v_mfma_f32_16x16x32_bf16 v[12:15], a[192:195], a[120:123], v[100:103]
    v_exp_f32 v19, v19
    v_mfma_f32_16x16x32_bf16 v[12:15], a[196:199], a[124:127], v[12:15]
    v_exp_f32 v20, v20
    v_mfma_f32_16x16x32_bf16 v[12:15], a[200:203], a[128:131], v[12:15]
    v_cvt_pk_bf16_f32 v40, v16, v17
    v_cvt_pk_bf16_f32 v41, v18, v19
    v_mfma_f32_16x16x32_bf16 a[0:3], v[192:195], v[32:35], a[0:3]
    v_exp_f32 v21, v21
    v_mfma_f32_16x16x32_bf16 a[4:7], v[196:199], v[32:35], a[4:7]
    v_exp_f32 v22, v22
    v_mfma_f32_16x16x32_bf16 a[8:11], v[200:203], v[32:35], a[8:11]
    v_exp_f32 v23, v23
    v_mfma_f32_16x16x32_bf16 a[12:15], v[204:207], v[32:35], a[12:15]
    buffer_load_dwordx4 v[216:219], v4, s[28:31], s60 offen offset:2048
    v_mfma_f32_16x16x32_bf16 a[16:19], v[208:211], v[32:35], a[16:19]
    v_cvt_pk_bf16_f32 v42, v20, v21
    v_cvt_pk_bf16_f32 v43, v22, v23
    v_mfma_f32_16x16x32_bf16 a[20:23], v[212:215], v[32:35], a[20:23]
    buffer_load_dwordx4 v[220:223], v4, s[28:31], s60 offen offset:3072
    v_mfma_f32_16x16x32_bf16 v[16:19], a[180:183], a[132:135], v[104:107]
    v_exp_f32 v8, v8
    v_mfma_f32_16x16x32_bf16 v[16:19], a[184:187], a[136:139], v[16:19]
    v_exp_f32 v9, v9
    v_mfma_f32_16x16x32_bf16 v[16:19], a[188:191], a[140:143], v[16:19]
    v_exp_f32 v10, v10
    v_mfma_f32_16x16x32_bf16 v[20:23], a[192:195], a[132:135], v[104:107]
    v_exp_f32 v11, v11
    v_mfma_f32_16x16x32_bf16 v[20:23], a[196:199], a[136:139], v[20:23]
    v_exp_f32 v12, v12
    v_mfma_f32_16x16x32_bf16 v[20:23], a[200:203], a[140:143], v[20:23]
    v_cvt_pk_bf16_f32 v48, v8, v9
    v_cvt_pk_bf16_f32 v49, v10, v11
    v_mfma_f32_16x16x32_bf16 a[24:27], v[192:195], v[40:43], a[24:27]
    v_exp_f32 v13, v13
    v_mfma_f32_16x16x32_bf16 a[28:31], v[196:199], v[40:43], a[28:31]
    v_exp_f32 v14, v14
    v_mfma_f32_16x16x32_bf16 a[32:35], v[200:203], v[40:43], a[32:35]
    v_exp_f32 v15, v15
    v_mfma_f32_16x16x32_bf16 a[36:39], v[204:207], v[40:43], a[36:39]
    buffer_load_dwordx4 v[224:227], v5, s[28:31], s60 offen offset:0
    v_mfma_f32_16x16x32_bf16 a[40:43], v[208:211], v[40:43], a[40:43]
    v_cvt_pk_bf16_f32 v50, v12, v13
    v_cvt_pk_bf16_f32 v51, v14, v15
    v_mfma_f32_16x16x32_bf16 a[44:47], v[212:215], v[40:43], a[44:47]
    buffer_load_dwordx4 v[228:231], v5, s[28:31], s60 offen offset:1024
    v_mfma_f32_16x16x32_bf16 v[8:11], a[180:183], a[144:147], v[108:111]
    v_exp_f32 v16, v16
    v_mfma_f32_16x16x32_bf16 v[8:11], a[184:187], a[148:151], v[8:11]
    v_exp_f32 v17, v17
    v_mfma_f32_16x16x32_bf16 v[8:11], a[188:191], a[152:155], v[8:11]
    v_exp_f32 v18, v18
    v_mfma_f32_16x16x32_bf16 v[12:15], a[192:195], a[144:147], v[108:111]
    v_exp_f32 v19, v19
    v_mfma_f32_16x16x32_bf16 v[12:15], a[196:199], a[148:151], v[12:15]
    v_exp_f32 v20, v20
    v_mfma_f32_16x16x32_bf16 v[12:15], a[200:203], a[152:155], v[12:15]
    v_cvt_pk_bf16_f32 v56, v16, v17
    v_cvt_pk_bf16_f32 v57, v18, v19
    v_mfma_f32_16x16x32_bf16 a[48:51], v[192:195], v[48:51], a[48:51]
    v_exp_f32 v21, v21
    v_mfma_f32_16x16x32_bf16 a[52:55], v[196:199], v[48:51], a[52:55]
    v_exp_f32 v22, v22
    v_mfma_f32_16x16x32_bf16 a[56:59], v[200:203], v[48:51], a[56:59]
    v_exp_f32 v23, v23
    v_mfma_f32_16x16x32_bf16 a[60:63], v[204:207], v[48:51], a[60:63]
    buffer_load_dwordx4 v[232:235], v5, s[28:31], s60 offen offset:2048
    v_mfma_f32_16x16x32_bf16 a[64:67], v[208:211], v[48:51], a[64:67]
    v_cvt_pk_bf16_f32 v58, v20, v21
    v_cvt_pk_bf16_f32 v59, v22, v23
    v_mfma_f32_16x16x32_bf16 a[68:71], v[212:215], v[48:51], a[68:71]
    buffer_load_dwordx4 v[236:239], v5, s[28:31], s60 offen offset:3072
    s_add_u32 s60, s60, 36864
    s_waitcnt vmcnt(6)
    v_mfma_f32_16x16x32_bf16 v[16:19], a[180:183], a[156:159], v[112:115]
    v_exp_f32 v8, v8
    v_mfma_f32_16x16x32_bf16 v[16:19], a[184:187], a[160:163], v[16:19]
    v_exp_f32 v9, v9
    v_mfma_f32_16x16x32_bf16 v[16:19], a[188:191], a[164:167], v[16:19]
    v_exp_f32 v10, v10
    v_mfma_f32_16x16x32_bf16 v[20:23], a[192:195], a[156:159], v[112:115]
    v_exp_f32 v11, v11
    v_mfma_f32_16x16x32_bf16 v[20:23], a[196:199], a[160:163], v[20:23]
    v_exp_f32 v12, v12
    v_mfma_f32_16x16x32_bf16 v[20:23], a[200:203], a[164:167], v[20:23]
    v_cvt_pk_bf16_f32 v64, v8, v9
    v_cvt_pk_bf16_f32 v65, v10, v11
    v_cmp_eq_u32 vcc, 0, v89
    v_mfma_f32_16x16x32_bf16 v[120:123], v[192:195], v[56:59], v[120:123]
    v_exp_f32 v13, v13
    v_mfma_f32_16x16x32_bf16 v[124:127], v[196:199], v[56:59], v[124:127]
    v_exp_f32 v14, v14
    s_cbranch_vccnz L_slowNone
L_backNone:
    v_mfma_f32_16x16x32_bf16 v[128:131], v[200:203], v[56:59], v[128:131]
    v_exp_f32 v15, v15
    v_mfma_f32_16x16x32_bf16 v[132:135], v[204:207], v[56:59], v[132:135]
    buffer_load_dwordx4 a[180:183], v3, s[28:31], s60 offen offset:0
    v_mfma_f32_16x16x32_bf16 v[136:139], v[208:211], v[56:59], v[136:139]
    v_cvt_pk_bf16_f32 v66, v12, v13
    v_cvt_pk_bf16_f32 v67, v14, v15
    v_mfma_f32_16x16x32_bf16 v[140:143], v[212:215], v[56:59], v[140:143]
    buffer_load_dwordx4 a[184:187], v3, s[28:31], s60 offen offset:1024
    v_mfma_f32_16x16x32_bf16 v[8:11], a[204:207], a[96:99], v[92:95]
    v_exp_f32 v16, v16
    v_mfma_f32_16x16x32_bf16 v[8:11], a[208:211], a[100:103], v[8:11]
    v_exp_f32 v17, v17
    v_mfma_f32_16x16x32_bf16 v[8:11], a[212:215], a[104:107], v[8:11]
    v_exp_f32 v18, v18
    v_mfma_f32_16x16x32_bf16 v[12:15], a[216:219], a[96:99], v[92:95]
    v_exp_f32 v19, v19
    v_mfma_f32_16x16x32_bf16 v[12:15], a[220:223], a[100:103], v[12:15]
    v_exp_f32 v20, v20
    v_mfma_f32_16x16x32_bf16 v[12:15], a[224:227], a[104:107], v[12:15]
    v_cvt_pk_bf16_f32 v72, v16, v17
    v_cvt_pk_bf16_f32 v73, v18, v19
    v_mfma_f32_16x16x32_bf16 v[144:147], v[192:195], v[64:67], v[144:147]
    v_exp_f32 v21, v21
    v_mfma_f32_16x16x32_bf16 v[148:151], v[196:199], v[64:67], v[148:151]
    v_exp_f32 v22, v22
    v_mfma_f32_16x16x32_bf16 v[152:155], v[200:203], v[64:67], v[152:155]
    v_exp_f32 v23, v23
    v_mfma_f32_16x16x32_bf16 v[156:159], v[204:207], v[64:67], v[156:159]
    buffer_load_dwordx4 a[188:191], v3, s[28:31], s60 offen offset:2048
    v_mfma_f32_16x16x32_bf16 v[160:163], v[208:211], v[64:67], v[160:163]
    v_cvt_pk_bf16_f32 v74, v20, v21
    v_cvt_pk_bf16_f32 v75, v22, v23
    v_mfma_f32_16x16x32_bf16 v[164:167], v[212:215], v[64:67], v[164:167]
    buffer_load_dwordx4 a[192:195], v3, s[28:31], s60 offen offset:3072
    v_mfma_f32_16x16x32_bf16 v[16:19], a[204:207], a[108:111], v[96:99]
    v_exp_f32 v8, v8
    v_mfma_f32_16x16x32_bf16 v[16:19], a[208:211], a[112:115], v[16:19]
    v_exp_f32 v9, v9
    v_mfma_f32_16x16x32_bf16 v[16:19], a[212:215], a[116:119], v[16:19]
    v_exp_f32 v10, v10
    v_mfma_f32_16x16x32_bf16 v[20:23], a[216:219], a[108:111], v[96:99]
    v_exp_f32 v11, v11
    v_mfma_f32_16x16x32_bf16 v[20:23], a[220:223], a[112:115], v[20:23]
    v_exp_f32 v12, v12
    v_mfma_f32_16x16x32_bf16 v[20:23], a[224:227], a[116:119], v[20:23]
    v_cvt_pk_bf16_f32 v36, v8, v9
    v_cvt_pk_bf16_f32 v37, v10, v11
    v_mfma_f32_16x16x32_bf16 v[168:171], v[192:195], v[72:75], v[168:171]
    v_exp_f32 v13, v13
    v_mfma_f32_16x16x32_bf16 v[172:175], v[196:199], v[72:75], v[172:175]
    v_exp_f32 v14, v14
    v_mfma_f32_16x16x32_bf16 v[176:179], v[200:203], v[72:75], v[176:179]
    v_exp_f32 v15, v15
    v_mfma_f32_16x16x32_bf16 v[180:183], v[204:207], v[72:75], v[180:183]
    buffer_load_dwordx4 a[196:199], v4, s[28:31], s60 offen offset:0
    v_mfma_f32_16x16x32_bf16 v[184:187], v[208:211], v[72:75], v[184:187]
    v_cvt_pk_bf16_f32 v38, v12, v13
    v_cvt_pk_bf16_f32 v39, v14, v15
    v_mfma_f32_16x16x32_bf16 v[188:191], v[212:215], v[72:75], v[188:191]
    buffer_load_dwordx4 a[200:203], v4, s[28:31], s60 offen offset:1024
    s_waitcnt vmcnt(6)
    v_mfma_f32_16x16x32_bf16 v[8:11], a[204:207], a[120:123], v[100:103]
    v_exp_f32 v16, v16
    v_mfma_f32_16x16x32_bf16 v[8:11], a[208:211], a[124:127], v[8:11]
    v_exp_f32 v17, v17
    v_mfma_f32_16x16x32_bf16 v[8:11], a[212:215], a[128:131], v[8:11]
    v_exp_f32 v18, v18
    v_mfma_f32_16x16x32_bf16 v[12:15], a[216:219], a[120:123], v[100:103]
    v_exp_f32 v19, v19
    v_mfma_f32_16x16x32_bf16 v[12:15], a[220:223], a[124:127], v[12:15]
    v_exp_f32 v20, v20
    v_mfma_f32_16x16x32_bf16 v[12:15], a[224:227], a[128:131], v[12:15]
    v_cvt_pk_bf16_f32 v44, v16, v17
    v_cvt_pk_bf16_f32 v45, v18, v19
    v_mfma_f32_16x16x32_bf16 a[0:3], v[216:219], v[36:39], a[0:3]
    v_exp_f32 v21, v21
    v_mfma_f32_16x16x32_bf16 a[4:7], v[220:223], v[36:39], a[4:7]
    v_exp_f32 v22, v22
    v_mfma_f32_16x16x32_bf16 a[8:11], v[224:227], v[36:39], a[8:11]
    v_exp_f32 v23, v23
    v_mfma_f32_16x16x32_bf16 a[12:15], v[228:231], v[36:39], a[12:15]
    buffer_load_dwordx4 v[192:195], v4, s[28:31], s60 offen offset:2048
    v_mfma_f32_16x16x32_bf16 a[16:19], v[232:235], v[36:39], a[16:19]
    v_cvt_pk_bf16_f32 v46, v20, v21
    v_cvt_pk_bf16_f32 v47, v22, v23
    v_mfma_f32_16x16x32_bf16 a[20:23], v[236:239], v[36:39], a[20:23]
    buffer_load_dwordx4 v[196:199], v4, s[28:31], s60 offen offset:3072
    v_smfmac_f32_16x16x64_bf16 a[228:231], v[84:87], v[32:39], v88
    s_sub_u32 s61, s61, 1
    v_mfma_f32_16x16x32_bf16 v[16:19], a[204:207], a[132:135], v[104:107]
    v_exp_f32 v8, v8
    v_mfma_f32_16x16x32_bf16 v[16:19], a[208:211], a[136:139], v[16:19]
    v_exp_f32 v9, v9
    v_mfma_f32_16x16x32_bf16 v[16:19], a[212:215], a[140:143], v[16:19]
    v_exp_f32 v10, v10
    v_mfma_f32_16x16x32_bf16 v[20:23], a[216:219], a[132:135], v[104:107]
    v_exp_f32 v11, v11
    v_mfma_f32_16x16x32_bf16 v[20:23], a[220:223], a[136:139], v[20:23]
    v_exp_f32 v12, v12
    v_mfma_f32_16x16x32_bf16 v[20:23], a[224:227], a[140:143], v[20:23]
    v_cvt_pk_bf16_f32 v52, v8, v9
    v_cvt_pk_bf16_f32 v53, v10, v11
    v_mfma_f32_16x16x32_bf16 a[24:27], v[216:219], v[44:47], a[24:27]
    v_exp_f32 v13, v13
    v_mfma_f32_16x16x32_bf16 a[28:31], v[220:223], v[44:47], a[28:31]
    v_exp_f32 v14, v14
    v_mfma_f32_16x16x32_bf16 a[32:35], v[224:227], v[44:47], a[32:35]
    v_exp_f32 v15, v15
    v_mfma_f32_16x16x32_bf16 a[36:39], v[228:231], v[44:47], a[36:39]
    buffer_load_dwordx4 v[200:203], v5, s[28:31], s60 offen offset:0
    v_mfma_f32_16x16x32_bf16 a[40:43], v[232:235], v[44:47], a[40:43]
    v_cvt_pk_bf16_f32 v54, v12, v13
    v_cvt_pk_bf16_f32 v55, v14, v15
    v_mfma_f32_16x16x32_bf16 a[44:47], v[236:239], v[44:47], a[44:47]
    buffer_load_dwordx4 v[204:207], v5, s[28:31], s60 offen offset:1024
    v_smfmac_f32_16x16x64_bf16 a[232:235], v[84:87], v[40:47], v88
    s_cmp_eq_u32 s61, 6
    s_cbranch_scc1 L_fvNone
L_fvbNone:
    v_mfma_f32_16x16x32_bf16 v[8:11], a[204:207], a[144:147], v[108:111]
    v_exp_f32 v16, v16
    v_mfma_f32_16x16x32_bf16 v[8:11], a[208:211], a[148:151], v[8:11]
    v_exp_f32 v17, v17
    v_mfma_f32_16x16x32_bf16 v[8:11], a[212:215], a[152:155], v[8:11]
    v_exp_f32 v18, v18
    v_mfma_f32_16x16x32_bf16 v[12:15], a[216:219], a[144:147], v[108:111]
    v_exp_f32 v19, v19
    v_mfma_f32_16x16x32_bf16 v[12:15], a[220:223], a[148:151], v[12:15]
    v_exp_f32 v20, v20
    v_mfma_f32_16x16x32_bf16 v[12:15], a[224:227], a[152:155], v[12:15]
    v_cvt_pk_bf16_f32 v60, v16, v17
    v_cvt_pk_bf16_f32 v61, v18, v19
    v_mfma_f32_16x16x32_bf16 a[48:51], v[216:219], v[52:55], a[48:51]
    v_exp_f32 v21, v21
    v_mfma_f32_16x16x32_bf16 a[52:55], v[220:223], v[52:55], a[52:55]
    v_exp_f32 v22, v22
    v_mfma_f32_16x16x32_bf16 a[56:59], v[224:227], v[52:55], a[56:59]
    v_exp_f32 v23, v23
    v_mfma_f32_16x16x32_bf16 a[60:63], v[228:231], v[52:55], a[60:63]
    buffer_load_dwordx4 v[208:211], v5, s[28:31], s60 offen offset:2048
    v_mfma_f32_16x16x32_bf16 a[64:67], v[232:235], v[52:55], a[64:67]
    v_cvt_pk_bf16_f32 v62, v20, v21
    v_cvt_pk_bf16_f32 v63, v22, v23
    v_mfma_f32_16x16x32_bf16 a[68:71], v[236:239], v[52:55], a[68:71]
    buffer_load_dwordx4 v[212:215], v5, s[28:31], s60 offen offset:3072
    v_smfmac_f32_16x16x64_bf16 a[236:239], v[84:87], v[48:55], v88
    s_add_u32 s60, s60, 12288
    s_waitcnt vmcnt(6)
    v_mfma_f32_16x16x32_bf16 v[16:19], a[204:207], a[156:159], v[112:115]
    v_exp_f32 v8, v8
    v_mfma_f32_16x16x32_bf16 v[16:19], a[208:211], a[160:163], v[16:19]
    v_exp_f32 v9, v9
    v_mfma_f32_16x16x32_bf16 v[16:19], a[212:215], a[164:167], v[16:19]
    v_exp_f32 v10, v10
    v_mfma_f32_16x16x32_bf16 v[20:23], a[216:219], a[156:159], v[112:115]
    v_exp_f32 v11, v11
    v_mfma_f32_16x16x32_bf16 v[20:23], a[220:223], a[160:163], v[20:23]
    v_exp_f32 v12, v12
    v_mfma_f32_16x16x32_bf16 v[20:23], a[224:227], a[164:167], v[20:23]
    v_cvt_pk_bf16_f32 v68, v8, v9
    v_cvt_pk_bf16_f32 v69, v10, v11
    v_mfma_f32_16x16x32_bf16 v[120:123], v[216:219], v[60:63], v[120:123]
    v_exp_f32 v13, v13
    v_mfma_f32_16x16x32_bf16 v[124:127], v[220:223], v[60:63], v[124:127]
    v_exp_f32 v14, v14
    v_mfma_f32_16x16x32_bf16 v[128:131], v[224:227], v[60:63], v[128:131]
    v_exp_f32 v15, v15
    v_mfma_f32_16x16x32_bf16 v[132:135], v[228:231], v[60:63], v[132:135]
    buffer_load_dwordx4 a[204:207], v3, s[28:31], s60 offen offset:0
    v_mfma_f32_16x16x32_bf16 v[136:139], v[232:235], v[60:63], v[136:139]
    v_cvt_pk_bf16_f32 v70, v12, v13
    v_cvt_pk_bf16_f32 v71, v14, v15
    s_cmp_lg_u32 s61, 0
    v_mfma_f32_16x16x32_bf16 v[140:143], v[236:239], v[60:63], v[140:143]
    buffer_load_dwordx4 a[208:211], v3, s[28:31], s60 offen offset:1024
    v_smfmac_f32_16x16x64_bf16 a[240:243], v[84:87], v[56:63], v88
    s_cbranch_scc1 L_loop2
    v_mfma_f32_16x16x32_bf16 v[8:11], a[180:183], a[96:99], v[92:95]
    v_exp_f32 v16, v16
    v_mfma_f32_16x16x32_bf16 v[8:11], a[184:187], a[100:103], v[8:11]
    v_exp_f32 v17, v17
    v_mfma_f32_16x16x32_bf16 v[8:11], a[188:191], a[104:107], v[8:11]
    v_exp_f32 v18, v18
    v_mfma_f32_16x16x32_bf16 v[12:15], a[192:195], a[96:99], v[92:95]
    v_exp_f32 v19, v19
    v_mfma_f32_16x16x32_bf16 v[12:15], a[196:199], a[100:103], v[12:15]
    v_exp_f32 v20, v20
    v_mfma_f32_16x16x32_bf16 v[12:15], a[200:203], a[104:107], v[12:15]
    v_cvt_pk_bf16_f32 v76, v16, v17
    v_cvt_pk_bf16_f32 v77, v18, v19
    v_mfma_f32_16x16x32_bf16 v[144:147], v[216:219], v[68:71], v[144:147]
    v_exp_f32 v21, v21
    v_mfma_f32_16x16x32_bf16 v[148:151], v[220:223], v[68:71], v[148:151]
    v_exp_f32 v22, v22
    v_mfma_f32_16x16x32_bf16 v[152:155], v[224:227], v[68:71], v[152:155]
    v_exp_f32 v23, v23
    v_mfma_f32_16x16x32_bf16 v[156:159], v[228:231], v[68:71], v[156:159]
    buffer_load_dwordx4 a[212:215], v3, s[28:31], s60 offen offset:2048
    v_mfma_f32_16x16x32_bf16 v[160:163], v[232:235], v[68:71], v[160:163]
    v_cvt_pk_bf16_f32 v78, v20, v21
    v_cvt_pk_bf16_f32 v79, v22, v23
    v_mfma_f32_16x16x32_bf16 v[164:167], v[236:239], v[68:71], v[164:167]
    buffer_load_dwordx4 a[216:219], v3, s[28:31], s60 offen offset:3072
    v_smfmac_f32_16x16x64_bf16 a[244:247], v[84:87], v[64:71], v88
    v_mfma_f32_16x16x32_bf16 v[16:19], a[180:183], a[108:111], v[96:99]
    v_exp_f32 v8, v8
    v_mfma_f32_16x16x32_bf16 v[16:19], a[184:187], a[112:115], v[16:19]
    v_exp_f32 v9, v9
    v_mfma_f32_16x16x32_bf16 v[16:19], a[188:191], a[116:119], v[16:19]
    v_exp_f32 v10, v10
    v_mfma_f32_16x16x32_bf16 v[20:23], a[192:195], a[108:111], v[96:99]
    v_exp_f32 v11, v11
    v_mfma_f32_16x16x32_bf16 v[20:23], a[196:199], a[112:115], v[20:23]
    v_exp_f32 v12, v12
    v_mfma_f32_16x16x32_bf16 v[20:23], a[200:203], a[116:119], v[20:23]
    v_cvt_pk_bf16_f32 v32, v8, v9
    v_cvt_pk_bf16_f32 v33, v10, v11
    v_mfma_f32_16x16x32_bf16 v[168:171], v[216:219], v[76:79], v[168:171]
    v_exp_f32 v13, v13
    v_mfma_f32_16x16x32_bf16 v[172:175], v[220:223], v[76:79], v[172:175]
    v_exp_f32 v14, v14
    v_mfma_f32_16x16x32_bf16 v[176:179], v[224:227], v[76:79], v[176:179]
    v_exp_f32 v15, v15
    v_mfma_f32_16x16x32_bf16 v[180:183], v[228:231], v[76:79], v[180:183]
    buffer_load_dwordx4 a[220:223], v4, s[28:31], s60 offen offset:0
    v_mfma_f32_16x16x32_bf16 v[184:187], v[232:235], v[76:79], v[184:187]
    v_cvt_pk_bf16_f32 v34, v12, v13
    v_cvt_pk_bf16_f32 v35, v14, v15
    v_mfma_f32_16x16x32_bf16 v[188:191], v[236:239], v[76:79], v[188:191]
    buffer_load_dwordx4 a[224:227], v4, s[28:31], s60 offen offset:1024
    v_smfmac_f32_16x16x64_bf16 a[248:251], v[84:87], v[72:79], v88
    s_waitcnt vmcnt(6)
    v_mfma_f32_16x16x32_bf16 v[8:11], a[180:183], a[120:123], v[100:103]
    v_exp_f32 v16, v16
    v_mfma_f32_16x16x32_bf16 v[8:11], a[184:187], a[124:127], v[8:11]
    v_exp_f32 v17, v17
    v_mfma_f32_16x16x32_bf16 v[8:11], a[188:191], a[128:131], v[8:11]
    v_exp_f32 v18, v18
    v_mfma_f32_16x16x32_bf16 v[12:15], a[192:195], a[120:123], v[100:103]
    v_exp_f32 v19, v19
    v_mfma_f32_16x16x32_bf16 v[12:15], a[196:199], a[124:127], v[12:15]
    v_exp_f32 v20, v20
    v_mfma_f32_16x16x32_bf16 v[12:15], a[200:203], a[128:131], v[12:15]
    v_cvt_pk_bf16_f32 v40, v16, v17
    v_cvt_pk_bf16_f32 v41, v18, v19
    v_mfma_f32_16x16x32_bf16 a[0:3], v[192:195], v[32:35], a[0:3]
    v_exp_f32 v21, v21
    v_mfma_f32_16x16x32_bf16 a[4:7], v[196:199], v[32:35], a[4:7]
    v_exp_f32 v22, v22
    buffer_load_dwordx4 v[216:219], v4, s[28:31], s60 offen offset:2048
    v_mfma_f32_16x16x32_bf16 a[8:11], v[200:203], v[32:35], a[8:11]
    v_exp_f32 v23, v23
    v_mfma_f32_16x16x32_bf16 a[12:15], v[204:207], v[32:35], a[12:15]
    buffer_load_dwordx4 v[220:223], v4, s[28:31], s60 offen offset:3072
    v_mfma_f32_16x16x32_bf16 a[16:19], v[208:211], v[32:35], a[16:19]
    v_cvt_pk_bf16_f32 v42, v20, v21
    v_cvt_pk_bf16_f32 v43, v22, v23
    v_mfma_f32_16x16x32_bf16 a[20:23], v[212:215], v[32:35], a[20:23]
    buffer_load_dwordx4 v[224:227], v5, s[28:31], s60 offen offset:0
    v_mfma_f32_16x16x32_bf16 v[16:19], a[180:183], a[132:135], v[104:107]
    v_exp_f32 v8, v8
    v_mfma_f32_16x16x32_bf16 v[16:19], a[184:187], a[136:139], v[16:19]
    v_exp_f32 v9, v9
    v_mfma_f32_16x16x32_bf16 v[16:19], a[188:191], a[140:143], v[16:19]
    v_exp_f32 v10, v10
    v_mfma_f32_16x16x32_bf16 v[20:23], a[192:195], a[132:135], v[104:107]
    v_exp_f32 v11, v11
    v_mfma_f32_16x16x32_bf16 v[20:23], a[196:199], a[136:139], v[20:23]
    v_exp_f32 v12, v12
    v_mfma_f32_16x16x32_bf16 v[20:23], a[200:203], a[140:143], v[20:23]
    v_cvt_pk_bf16_f32 v48, v8, v9
    v_cvt_pk_bf16_f32 v49, v10, v11
    v_mfma_f32_16x16x32_bf16 a[24:27], v[192:195], v[40:43], a[24:27]
    v_exp_f32 v13, v13
    v_mfma_f32_16x16x32_bf16 a[28:31], v[196:199], v[40:43], a[28:31]
    v_exp_f32 v14, v14
    buffer_load_dwordx4 v[228:231], v5, s[28:31], s60 offen offset:1024
    v_mfma_f32_16x16x32_bf16 a[32:35], v[200:203], v[40:43], a[32:35]
    v_exp_f32 v15, v15
    v_mfma_f32_16x16x32_bf16 a[36:39], v[204:207], v[40:43], a[36:39]
    buffer_load_dwordx4 v[232:235], v5, s[28:31], s60 offen offset:2048
    v_mfma_f32_16x16x32_bf16 a[40:43], v[208:211], v[40:43], a[40:43]
    v_cvt_pk_bf16_f32 v50, v12, v13
    v_cvt_pk_bf16_f32 v51, v14, v15
    v_mfma_f32_16x16x32_bf16 a[44:47], v[212:215], v[40:43], a[44:47]
    buffer_load_dwordx4 v[236:239], v5, s[28:31], s60 offen offset:3072
    s_waitcnt vmcnt(6)
    v_mfma_f32_16x16x32_bf16 v[8:11], a[204:207], a[96:99], v[92:95]
    v_exp_f32 v16, v16
    v_mfma_f32_16x16x32_bf16 v[8:11], a[208:211], a[100:103], v[8:11]
    v_exp_f32 v17, v17
    v_mfma_f32_16x16x32_bf16 v[8:11], a[212:215], a[104:107], v[8:11]
    v_exp_f32 v18, v18
    v_mfma_f32_16x16x32_bf16 v[12:15], a[216:219], a[96:99], v[92:95]
    v_exp_f32 v19, v19
    v_mfma_f32_16x16x32_bf16 v[12:15], a[220:223], a[100:103], v[12:15]
    v_exp_f32 v20, v20
    v_mfma_f32_16x16x32_bf16 v[12:15], a[224:227], a[104:107], v[12:15]
    v_cvt_pk_bf16_f32 v56, v16, v17
    v_cvt_pk_bf16_f32 v57, v18, v19
    v_mfma_f32_16x16x32_bf16 a[48:51], v[192:195], v[48:51], a[48:51]
    v_exp_f32 v21, v21
    v_mfma_f32_16x16x32_bf16 a[52:55], v[196:199], v[48:51], a[52:55]
    v_exp_f32 v22, v22
    v_mfma_f32_16x16x32_bf16 a[56:59], v[200:203], v[48:51], a[56:59]
    v_exp_f32 v23, v23
    v_mfma_f32_16x16x32_bf16 a[60:63], v[204:207], v[48:51], a[60:63]
    v_mfma_f32_16x16x32_bf16 a[64:67], v[208:211], v[48:51], a[64:67]
    v_cvt_pk_bf16_f32 v58, v20, v21
    v_cvt_pk_bf16_f32 v59, v22, v23
    v_mfma_f32_16x16x32_bf16 a[68:71], v[212:215], v[48:51], a[68:71]
    v_mfma_f32_16x16x32_bf16 v[16:19], a[204:207], a[108:111], v[96:99]
    v_exp_f32 v8, v8
    v_mfma_f32_16x16x32_bf16 v[16:19], a[208:211], a[112:115], v[16:19]
    v_exp_f32 v9, v9
    v_mfma_f32_16x16x32_bf16 v[16:19], a[212:215], a[116:119], v[16:19]
    v_exp_f32 v10, v10
    v_mfma_f32_16x16x32_bf16 v[20:23], a[216:219], a[108:111], v[96:99]
    v_exp_f32 v11, v11
    v_mfma_f32_16x16x32_bf16 v[20:23], a[220:223], a[112:115], v[20:23]
    v_exp_f32 v12, v12
    v_mfma_f32_16x16x32_bf16 v[20:23], a[224:227], a[116:119], v[20:23]
    v_cvt_pk_bf16_f32 v36, v8, v9
    v_cvt_pk_bf16_f32 v37, v10, v11
    v_mfma_f32_16x16x32_bf16 v[120:123], v[192:195], v[56:59], v[120:123]
    v_exp_f32 v13, v13
    v_mfma_f32_16x16x32_bf16 v[124:127], v[196:199], v[56:59], v[124:127]
    v_exp_f32 v14, v14
    v_mfma_f32_16x16x32_bf16 v[128:131], v[200:203], v[56:59], v[128:131]
    v_exp_f32 v15, v15
    v_mfma_f32_16x16x32_bf16 v[132:135], v[204:207], v[56:59], v[132:135]
    v_mfma_f32_16x16x32_bf16 v[136:139], v[208:211], v[56:59], v[136:139]
    v_cvt_pk_bf16_f32 v38, v12, v13
    v_cvt_pk_bf16_f32 v39, v14, v15
    v_mfma_f32_16x16x32_bf16 v[140:143], v[212:215], v[56:59], v[140:143]
    v_mfma_f32_16x16x32_bf16 v[8:11], a[204:207], a[120:123], v[100:103]
    v_exp_f32 v16, v16
    v_mfma_f32_16x16x32_bf16 v[8:11], a[208:211], a[124:127], v[8:11]
    v_exp_f32 v17, v17
    v_mfma_f32_16x16x32_bf16 v[8:11], a[212:215], a[128:131], v[8:11]
    v_exp_f32 v18, v18
    v_mfma_f32_16x16x32_bf16 v[12:15], a[216:219], a[120:123], v[100:103]
    v_exp_f32 v19, v19
    v_mfma_f32_16x16x32_bf16 v[12:15], a[220:223], a[124:127], v[12:15]
    v_exp_f32 v20, v20
    v_mfma_f32_16x16x32_bf16 v[12:15], a[224:227], a[128:131], v[12:15]
    v_cvt_pk_bf16_f32 v44, v16, v17
    v_cvt_pk_bf16_f32 v45, v18, v19
    s_waitcnt vmcnt(0)
    v_mfma_f32_16x16x32_bf16 a[0:3], v[216:219], v[36:39], a[0:3]
    v_exp_f32 v21, v21
    v_mfma_f32_16x16x32_bf16 a[4:7], v[220:223], v[36:39], a[4:7]
    v_exp_f32 v22, v22
    v_mfma_f32_16x16x32_bf16 a[8:11], v[224:227], v[36:39], a[8:11]
    v_exp_f32 v23, v23
    v_mfma_f32_16x16x32_bf16 a[12:15], v[228:231], v[36:39], a[12:15]
    v_mfma_f32_16x16x32_bf16 a[16:19], v[232:235], v[36:39], a[16:19]
    v_cvt_pk_bf16_f32 v46, v20, v21
    v_cvt_pk_bf16_f32 v47, v22, v23
    v_mfma_f32_16x16x32_bf16 a[20:23], v[236:239], v[36:39], a[20:23]
    ds_write_b128 v6, a[0:3] offset:0
    v_smfmac_f32_16x16x64_bf16 a[228:231], v[84:87], v[32:39], v88
    ds_write_b128 v6, a[4:7] offset:1024
    v_mfma_f32_16x16x32_bf16 v[16:19], a[180:183], a[144:147], v[108:111]
    v_exp_f32 v8, v8
    v_mfma_f32_16x16x32_bf16 v[16:19], a[184:187], a[148:151], v[16:19]
    v_exp_f32 v9, v9
    v_mfma_f32_16x16x32_bf16 v[16:19], a[188:191], a[152:155], v[16:19]
    v_exp_f32 v10, v10
    ds_write_b128 v6, a[8:11] offset:2048
    v_mfma_f32_16x16x32_bf16 v[20:23], a[192:195], a[144:147], v[108:111]
    v_exp_f32 v11, v11
    v_mfma_f32_16x16x32_bf16 v[20:23], a[196:199], a[148:151], v[20:23]
    v_exp_f32 v12, v12
    v_mfma_f32_16x16x32_bf16 v[20:23], a[200:203], a[152:155], v[20:23]
    v_cvt_pk_bf16_f32 v52, v8, v9
    v_cvt_pk_bf16_f32 v53, v10, v11
    ds_write_b128 v6, a[12:15] offset:3072
    v_mfma_f32_16x16x32_bf16 a[24:27], v[216:219], v[44:47], a[24:27]
    v_exp_f32 v13, v13
    v_mfma_f32_16x16x32_bf16 a[28:31], v[220:223], v[44:47], a[28:31]
    v_exp_f32 v14, v14
    v_mfma_f32_16x16x32_bf16 a[32:35], v[224:227], v[44:47], a[32:35]
    v_exp_f32 v15, v15
    v_mfma_f32_16x16x32_bf16 a[36:39], v[228:231], v[44:47], a[36:39]
    ds_write_b128 v6, a[16:19] offset:4096
    v_mfma_f32_16x16x32_bf16 a[40:43], v[232:235], v[44:47], a[40:43]
    v_cvt_pk_bf16_f32 v54, v12, v13
    v_cvt_pk_bf16_f32 v55, v14, v15
    v_mfma_f32_16x16x32_bf16 a[44:47], v[236:239], v[44:47], a[44:47]
    ds_write_b128 v6, a[20:23] offset:5120
    ds_write_b64 v6, a[228:229] offset:24576
    v_smfmac_f32_16x16x64_bf16 a[232:235], v[84:87], v[40:47], v88
    ds_write_b128 v6, a[24:27] offset:6144
    v_mfma_f32_16x16x32_bf16 v[8:11], a[180:183], a[156:159], v[112:115]
    v_exp_f32 v16, v16
    v_mfma_f32_16x16x32_bf16 v[8:11], a[184:187], a[160:163], v[8:11]
    v_exp_f32 v17, v17
    v_mfma_f32_16x16x32_bf16 v[8:11], a[188:191], a[164:167], v[8:11]
    v_exp_f32 v18, v18
    ds_write_b128 v6, a[28:31] offset:7168
    v_mfma_f32_16x16x32_bf16 v[12:15], a[192:195], a[156:159], v[112:115]
    v_exp_f32 v19, v19
    v_mfma_f32_16x16x32_bf16 v[12:15], a[196:199], a[160:163], v[12:15]
    v_exp_f32 v20, v20
    v_mfma_f32_16x16x32_bf16 v[12:15], a[200:203], a[164:167], v[12:15]
    v_cvt_pk_bf16_f32 v64, v16, v17
    v_cvt_pk_bf16_f32 v65, v18, v19
    ds_write_b128 v6, a[32:35] offset:8192
    v_mfma_f32_16x16x32_bf16 a[48:51], v[216:219], v[52:55], a[48:51]
    v_exp_f32 v21, v21
    v_mfma_f32_16x16x32_bf16 a[52:55], v[220:223], v[52:55], a[52:55]
    v_exp_f32 v22, v22
    v_mfma_f32_16x16x32_bf16 a[56:59], v[224:227], v[52:55], a[56:59]
    v_exp_f32 v23, v23
    v_mfma_f32_16x16x32_bf16 a[60:63], v[228:231], v[52:55], a[60:63]
    ds_write_b128 v6, a[36:39] offset:9216
    v_mfma_f32_16x16x32_bf16 a[64:67], v[232:235], v[52:55], a[64:67]
    v_cvt_pk_bf16_f32 v66, v20, v21
    v_cvt_pk_bf16_f32 v67, v22, v23
    v_mfma_f32_16x16x32_bf16 a[68:71], v[236:239], v[52:55], a[68:71]
    ds_write_b128 v6, a[40:43] offset:10240
    v_smfmac_f32_16x16x64_bf16 a[236:239], v[84:87], v[48:55], v88
    ds_write_b128 v6, a[44:47] offset:11264
    ds_write_b64 v6, a[232:233] offset:25600
    v_mfma_f32_16x16x32_bf16 v[16:19], a[204:207], a[132:135], v[104:107]
    v_exp_f32 v8, v8
    v_mfma_f32_16x16x32_bf16 v[16:19], a[208:211], a[136:139], v[16:19]
    v_exp_f32 v9, v9
    v_mfma_f32_16x16x32_bf16 v[16:19], a[212:215], a[140:143], v[16:19]
    v_exp_f32 v10, v10
    ds_write_b128 v6, a[48:51] offset:12288
    v_mfma_f32_16x16x32_bf16 v[20:23], a[216:219], a[132:135], v[104:107]
    v_exp_f32 v11, v11
    v_mfma_f32_16x16x32_bf16 v[20:23], a[220:223], a[136:139], v[20:23]
    v_exp_f32 v12, v12
    v_mfma_f32_16x16x32_bf16 v[20:23], a[224:227], a[140:143], v[20:23]
    v_cvt_pk_bf16_f32 v72, v8, v9
    v_cvt_pk_bf16_f32 v73, v10, v11
    ds_write_b128 v6, a[52:55] offset:13312
    v_mfma_f32_16x16x32_bf16 v[144:147], v[192:195], v[64:67], v[144:147]
    v_exp_f32 v13, v13
    v_mfma_f32_16x16x32_bf16 v[148:151], v[196:199], v[64:67], v[148:151]
    v_exp_f32 v14, v14
    v_mfma_f32_16x16x32_bf16 v[152:155], v[200:203], v[64:67], v[152:155]
    v_exp_f32 v15, v15
    v_mfma_f32_16x16x32_bf16 v[156:159], v[204:207], v[64:67], v[156:159]
    ds_write_b128 v6, a[56:59] offset:14336
    v_mfma_f32_16x16x32_bf16 v[160:163], v[208:211], v[64:67], v[160:163]
    v_cvt_pk_bf16_f32 v74, v12, v13
    v_cvt_pk_bf16_f32 v75, v14, v15
    v_mfma_f32_16x16x32_bf16 v[164:167], v[212:215], v[64:67], v[164:167]
    ds_write_b128 v6, a[60:63] offset:15360
    v_mfma_f32_16x16x32_bf16 v[8:11], a[204:207], a[144:147], v[108:111]
    v_exp_f32 v16, v16
    v_mfma_f32_16x16x32_bf16 v[8:11], a[208:211], a[148:151], v[8:11]
    v_exp_f32 v17, v17
    v_mfma_f32_16x16x32_bf16 v[8:11], a[212:215], a[152:155], v[8:11]
    v_exp_f32 v18, v18
    ds_write_b128 v6, a[64:67] offset:16384
    v_mfma_f32_16x16x32_bf16 v[12:15], a[216:219], a[144:147], v[108:111]
    v_exp_f32 v19, v19
    v_mfma_f32_16x16x32_bf16 v[12:15], a[220:223], a[148:151], v[12:15]
    v_exp_f32 v20, v20
    v_mfma_f32_16x16x32_bf16 v[12:15], a[224:227], a[152:155], v[12:15]
    v_cvt_pk_bf16_f32 v60, v16, v17
    v_cvt_pk_bf16_f32 v61, v18, v19
    ds_write_b128 v6, a[68:71] offset:17408
    ds_write_b64 v6, a[236:237] offset:26624
    v_mfma_f32_16x16x32_bf16 v[168:171], v[192:195], v[72:75], v[168:171]
    v_exp_f32 v21, v21
    v_mfma_f32_16x16x32_bf16 v[172:175], v[196:199], v[72:75], v[172:175]
    v_exp_f32 v22, v22
    v_mfma_f32_16x16x32_bf16 v[176:179], v[200:203], v[72:75], v[176:179]
    v_exp_f32 v23, v23
    v_mfma_f32_16x16x32_bf16 v[180:183], v[204:207], v[72:75], v[180:183]
    v_mfma_f32_16x16x32_bf16 v[184:187], v[208:211], v[72:75], v[184:187]
    v_cvt_pk_bf16_f32 v62, v20, v21
    v_cvt_pk_bf16_f32 v63, v22, v23
    v_mfma_f32_16x16x32_bf16 v[188:191], v[212:215], v[72:75], v[188:191]
    v_mfma_f32_16x16x32_bf16 v[16:19], a[204:207], a[156:159], v[112:115]
    v_exp_f32 v8, v8
    v_mfma_f32_16x16x32_bf16 v[16:19], a[208:211], a[160:163], v[16:19]
    v_exp_f32 v9, v9
    v_mfma_f32_16x16x32_bf16 v[16:19], a[212:215], a[164:167], v[16:19]
    v_exp_f32 v10, v10
    v_mfma_f32_16x16x32_bf16 v[20:23], a[216:219], a[156:159], v[112:115]
    v_exp_f32 v11, v11
    v_mfma_f32_16x16x32_bf16 v[20:23], a[220:223], a[160:163], v[20:23]
    v_exp_f32 v12, v12
    v_mfma_f32_16x16x32_bf16 v[20:23], a[224:227], a[164:167], v[20:23]
    v_cvt_pk_bf16_f32 v68, v8, v9
    v_cvt_pk_bf16_f32 v69, v10, v11
    v_mfma_f32_16x16x32_bf16 v[120:123], v[216:219], v[60:63], v[120:123]
    v_exp_f32 v13, v13
    v_mfma_f32_16x16x32_bf16 v[124:127], v[220:223], v[60:63], v[124:127]
    v_exp_f32 v14, v14
    v_mfma_f32_16x16x32_bf16 v[128:131], v[224:227], v[60:63], v[128:131]
    v_exp_f32 v15, v15
    s_waitcnt lgkmcnt(0)
    s_barrier
    v_mfma_f32_16x16x32_bf16 v[132:135], v[228:231], v[60:63], v[132:135]
    ds_read_b64 v[92:93], v7 offset:24576
    ds_read_b64 v[96:97], v7 offset:25600
    ds_read_b64 v[100:101], v7 offset:26624
    v_mfma_f32_16x16x32_bf16 v[136:139], v[232:235], v[60:63], v[136:139]
    v_cvt_pk_bf16_f32 v70, v12, v13
    v_cvt_pk_bf16_f32 v71, v14, v15
    v_mfma_f32_16x16x32_bf16 v[140:143], v[236:239], v[60:63], v[140:143]
    ds_read_b128 v[32:35], v7 offset:0
    ds_read_b128 v[36:39], v7 offset:1024
    ds_read_b128 v[40:43], v7 offset:2048
    v_smfmac_f32_16x16x64_bf16 a[240:243], v[84:87], v[56:63], v88
    ds_read_b128 v[44:47], v7 offset:3072
    ds_read_b128 v[48:51], v7 offset:4096
    ds_read_b128 v[52:55], v7 offset:5120
    v_mfma_f32_16x16x32_bf16 v[144:147], v[216:219], v[68:71], v[144:147]
    v_exp_f32 v16, v16
    v_exp_f32 v17, v17
    v_mfma_f32_16x16x32_bf16 v[148:151], v[220:223], v[68:71], v[148:151]
    v_exp_f32 v18, v18
    v_exp_f32 v19, v19
    v_mfma_f32_16x16x32_bf16 v[152:155], v[224:227], v[68:71], v[152:155]
    v_exp_f32 v20, v20
    v_cvt_pk_bf16_f32 v76, v16, v17
    v_mfma_f32_16x16x32_bf16 v[156:159], v[228:231], v[68:71], v[156:159]
    v_cvt_pk_bf16_f32 v77, v18, v19
    v_exp_f32 v21, v21
    v_mfma_f32_16x16x32_bf16 v[160:163], v[232:235], v[68:71], v[160:163]
    v_exp_f32 v22, v22
    v_exp_f32 v23, v23
    v_mfma_f32_16x16x32_bf16 v[164:167], v[236:239], v[68:71], v[164:167]
    v_cvt_pk_bf16_f32 v78, v20, v21
    v_cvt_pk_bf16_f32 v79, v22, v23
    v_smfmac_f32_16x16x64_bf16 a[244:247], v[84:87], v[64:71], v88
    ds_read_b128 v[192:195], v7 offset:6144
    ds_read_b128 v[196:199], v7 offset:7168
    ds_read_b128 v[200:203], v7 offset:8192
    v_mfma_f32_16x16x32_bf16 v[168:171], v[216:219], v[76:79], v[168:171]
    ds_read_b128 v[204:207], v7 offset:9216
    ds_read_b128 v[208:211], v7 offset:10240
    ds_read_b128 v[212:215], v7 offset:11264
    v_mfma_f32_16x16x32_bf16 v[172:175], v[220:223], v[76:79], v[172:175]
    s_waitcnt lgkmcnt(10)
    v_accvgpr_read_b32 v94, a240
    v_mfma_f32_16x16x32_bf16 v[176:179], v[224:227], v[76:79], v[176:179]
    v_accvgpr_read_b32 v95, a241
    v_add_f32 v92, v92, v93
    v_add_f32 v94, v94, v95
    v_mfma_f32_16x16x32_bf16 v[180:183], v[228:231], v[76:79], v[180:183]
    v_add_f32 v94, v94, v92
    v_rcp_f32 v95, v94
    v_mfma_f32_16x16x32_bf16 v[184:187], v[232:235], v[76:79], v[184:187]
    v_add_f32 v120, v120, v32
    v_add_f32 v121, v121, v33
    v_add_f32 v122, v122, v34
    v_mfma_f32_16x16x32_bf16 v[188:191], v[236:239], v[76:79], v[188:191]
    v_add_f32 v123, v123, v35
    v_add_f32 v124, v124, v36
    v_smfmac_f32_16x16x64_bf16 a[248:251], v[84:87], v[72:79], v88
    v_add_f32 v125, v125, v37
    v_add_f32 v126, v126, v38
    v_add_f32 v127, v127, v39
L_epi:
    v_pk_mul_f32 v[120:121], v[120:121], v[94:95] op_sel:[0,1] op_sel_hi:[1,1]
    v_pk_mul_f32 v[122:123], v[122:123], v[94:95] op_sel:[0,1] op_sel_hi:[1,1]
    v_pk_mul_f32 v[124:125], v[124:125], v[94:95] op_sel:[0,1] op_sel_hi:[1,1]
    v_pk_mul_f32 v[126:127], v[126:127], v[94:95] op_sel:[0,1] op_sel_hi:[1,1]
    v_cvt_pk_bf16_f32 v120, v120, v121
    v_cvt_pk_bf16_f32 v121, v122, v123
    v_cvt_pk_bf16_f32 v122, v124, v125
    v_cvt_pk_bf16_f32 v123, v126, v127
    buffer_store_dwordx4 v[120:123], v240, s[24:27], s47 offen offset:0 sc1 nt
    s_mov_b32 s48, 0x35800000
    s_mov_b32 s49, 0x6c800000
    s_mov_b64 s[64:65], 0
    v_add_u32 v28, 57344, v1
    v_add_u32 v29, 57344, v3
    s_waitcnt lgkmcnt(6)
    v_pk_add_f32 v[128:129], v[128:129], v[40:41]
    v_pk_add_f32 v[130:131], v[130:131], v[42:43]
    v_pk_add_f32 v[132:133], v[132:133], v[44:45]
    v_pk_add_f32 v[134:135], v[134:135], v[46:47]
    ds_read_b128 v[216:219], v7 offset:12288
    ds_read_b128 v[220:223], v7 offset:13312
    ds_read_b128 v[224:227], v7 offset:14336
    ds_read_b128 v[228:231], v7 offset:15360
    ds_read_b128 v[232:235], v7 offset:16384
    ds_read_b128 v[236:239], v7 offset:17408
    v_accvgpr_read_b32 v98, a244
    v_accvgpr_read_b32 v99, a245
    v_add_f32 v96, v96, v97
    v_add_f32 v98, v98, v99
    v_add_f32 v98, v98, v96
    v_rcp_f32 v99, v98
    v_pk_mul_f32 v[128:129], v[128:129], v[94:95] op_sel:[0,1] op_sel_hi:[1,1]
    v_pk_mul_f32 v[130:131], v[130:131], v[94:95] op_sel:[0,1] op_sel_hi:[1,1]
    v_pk_mul_f32 v[132:133], v[132:133], v[94:95] op_sel:[0,1] op_sel_hi:[1,1]
    v_pk_mul_f32 v[134:135], v[134:135], v[94:95] op_sel:[0,1] op_sel_hi:[1,1]
    v_cvt_pk_bf16_f32 v128, v128, v129
    v_cvt_pk_bf16_f32 v129, v130, v131
    v_cvt_pk_bf16_f32 v130, v132, v133
    v_cvt_pk_bf16_f32 v131, v134, v135
    buffer_store_dwordx4 v[128:131], v240, s[24:27], s47 offen offset:64 sc1 nt
    v_pk_add_f32 v[136:137], v[136:137], v[48:49]
    v_pk_add_f32 v[138:139], v[138:139], v[50:51]
    v_pk_add_f32 v[140:141], v[140:141], v[52:53]
    v_pk_add_f32 v[142:143], v[142:143], v[54:55]
    v_pk_mul_f32 v[136:137], v[136:137], v[94:95] op_sel:[0,1] op_sel_hi:[1,1]
    v_pk_mul_f32 v[138:139], v[138:139], v[94:95] op_sel:[0,1] op_sel_hi:[1,1]
    v_pk_mul_f32 v[140:141], v[140:141], v[94:95] op_sel:[0,1] op_sel_hi:[1,1]
    v_pk_mul_f32 v[142:143], v[142:143], v[94:95] op_sel:[0,1] op_sel_hi:[1,1]
    v_cvt_pk_bf16_f32 v136, v136, v137
    v_cvt_pk_bf16_f32 v137, v138, v139
    v_cvt_pk_bf16_f32 v138, v140, v141
    v_cvt_pk_bf16_f32 v139, v142, v143
    buffer_store_dwordx4 v[136:139], v240, s[24:27], s47 offen offset:128 sc1 nt
    s_waitcnt lgkmcnt(10)
    v_pk_add_f32 v[144:145], v[144:145], v[192:193]
    v_pk_add_f32 v[146:147], v[146:147], v[194:195]
    v_pk_add_f32 v[148:149], v[148:149], v[196:197]
    v_pk_add_f32 v[150:151], v[150:151], v[198:199]
    ds_read_b32 v24, v3 offset:27648
    ds_read_b32 v25, v3 offset:56320
    ds_read_b32 v26, v29 offset:27648
    ds_read_b32 v27, v29 offset:56320
    v_pk_mul_f32 v[144:145], v[144:145], v[98:99] op_sel:[0,1] op_sel_hi:[1,1]
    v_pk_mul_f32 v[146:147], v[146:147], v[98:99] op_sel:[0,1] op_sel_hi:[1,1]
    v_pk_mul_f32 v[148:149], v[148:149], v[98:99] op_sel:[0,1] op_sel_hi:[1,1]
    v_pk_mul_f32 v[150:151], v[150:151], v[98:99] op_sel:[0,1] op_sel_hi:[1,1]
    v_cvt_pk_bf16_f32 v144, v144, v145
    v_cvt_pk_bf16_f32 v145, v146, v147
    v_cvt_pk_bf16_f32 v146, v148, v149
    v_cvt_pk_bf16_f32 v147, v150, v151
    buffer_store_dwordx4 v[144:147], v241, s[24:27], s47 offen offset:0 sc1 nt
    s_waitcnt lgkmcnt(12)
    v_pk_add_f32 v[152:153], v[152:153], v[200:201]
    v_pk_add_f32 v[154:155], v[154:155], v[202:203]
    v_pk_add_f32 v[156:157], v[156:157], v[204:205]
    v_pk_add_f32 v[158:159], v[158:159], v[206:207]
    ds_read_b128 v[32:35], v1 offset:18432
    ds_read_b128 v[36:39], v1 offset:19456
    ds_read_b128 v[40:43], v1 offset:47104
    ds_read_b128 v[44:47], v1 offset:48128
    v_accvgpr_read_b32 v102, a248
    v_accvgpr_read_b32 v103, a249
    v_add_f32 v100, v100, v101
    v_add_f32 v102, v102, v103
    v_add_f32 v102, v102, v100
    v_rcp_f32 v103, v102
    v_pk_mul_f32 v[152:153], v[152:153], v[98:99] op_sel:[0,1] op_sel_hi:[1,1]
    v_pk_mul_f32 v[154:155], v[154:155], v[98:99] op_sel:[0,1] op_sel_hi:[1,1]
    v_pk_mul_f32 v[156:157], v[156:157], v[98:99] op_sel:[0,1] op_sel_hi:[1,1]
    v_pk_mul_f32 v[158:159], v[158:159], v[98:99] op_sel:[0,1] op_sel_hi:[1,1]
    v_cvt_pk_bf16_f32 v152, v152, v153
    v_cvt_pk_bf16_f32 v153, v154, v155
    v_cvt_pk_bf16_f32 v154, v156, v157
    v_cvt_pk_bf16_f32 v155, v158, v159
    buffer_store_dwordx4 v[152:155], v241, s[24:27], s47 offen offset:64 sc1 nt
    s_waitcnt lgkmcnt(14)
    v_pk_add_f32 v[160:161], v[160:161], v[208:209]
    v_pk_add_f32 v[162:163], v[162:163], v[210:211]
    v_pk_add_f32 v[164:165], v[164:165], v[212:213]
    v_pk_add_f32 v[166:167], v[166:167], v[214:215]
    ds_read_b128 v[48:51], v28 offset:18432
    ds_read_b128 v[52:55], v28 offset:19456
    ds_read_b128 v[56:59], v28 offset:47104
    ds_read_b128 v[60:63], v28 offset:48128
    v_pk_mul_f32 v[160:161], v[160:161], v[98:99] op_sel:[0,1] op_sel_hi:[1,1]
    v_pk_mul_f32 v[162:163], v[162:163], v[98:99] op_sel:[0,1] op_sel_hi:[1,1]
    v_pk_mul_f32 v[164:165], v[164:165], v[98:99] op_sel:[0,1] op_sel_hi:[1,1]
    v_pk_mul_f32 v[166:167], v[166:167], v[98:99] op_sel:[0,1] op_sel_hi:[1,1]
    v_cvt_pk_bf16_f32 v160, v160, v161
    v_cvt_pk_bf16_f32 v161, v162, v163
    v_cvt_pk_bf16_f32 v162, v164, v165
    v_cvt_pk_bf16_f32 v163, v166, v167
    buffer_store_dwordx4 v[160:163], v241, s[24:27], s47 offen offset:128 sc1 nt
    s_waitcnt lgkmcnt(15)
    v_pk_add_f32 v[168:169], v[168:169], v[216:217]
    v_pk_add_f32 v[170:171], v[170:171], v[218:219]
    v_pk_add_f32 v[172:173], v[172:173], v[220:221]
    v_pk_add_f32 v[174:175], v[174:175], v[222:223]
    v_pk_mul_f32 v[168:169], v[168:169], v[102:103] op_sel:[0,1] op_sel_hi:[1,1]
    v_pk_mul_f32 v[170:171], v[170:171], v[102:103] op_sel:[0,1] op_sel_hi:[1,1]
    v_pk_mul_f32 v[172:173], v[172:173], v[102:103] op_sel:[0,1] op_sel_hi:[1,1]
    v_pk_mul_f32 v[174:175], v[174:175], v[102:103] op_sel:[0,1] op_sel_hi:[1,1]
    v_cvt_pk_bf16_f32 v168, v168, v169
    v_cvt_pk_bf16_f32 v169, v170, v171
    v_cvt_pk_bf16_f32 v170, v172, v173
    v_cvt_pk_bf16_f32 v171, v174, v175
    buffer_store_dwordx4 v[168:171], v242, s[24:27], s47 offen offset:0 sc1 nt
    s_waitcnt lgkmcnt(14)
    v_pk_add_f32 v[176:177], v[176:177], v[224:225]
    v_pk_add_f32 v[178:179], v[178:179], v[226:227]
    v_pk_add_f32 v[180:181], v[180:181], v[228:229]
    v_pk_add_f32 v[182:183], v[182:183], v[230:231]
    v_pk_mul_f32 v[176:177], v[176:177], v[102:103] op_sel:[0,1] op_sel_hi:[1,1]
    v_pk_mul_f32 v[178:179], v[178:179], v[102:103] op_sel:[0,1] op_sel_hi:[1,1]
    v_pk_mul_f32 v[180:181], v[180:181], v[102:103] op_sel:[0,1] op_sel_hi:[1,1]
    v_pk_mul_f32 v[182:183], v[182:183], v[102:103] op_sel:[0,1] op_sel_hi:[1,1]
    v_cvt_pk_bf16_f32 v176, v176, v177
    v_cvt_pk_bf16_f32 v177, v178, v179
    v_cvt_pk_bf16_f32 v178, v180, v181
    v_cvt_pk_bf16_f32 v179, v182, v183
    buffer_store_dwordx4 v[176:179], v242, s[24:27], s47 offen offset:64 sc1 nt
    s_waitcnt lgkmcnt(12)
    v_pk_add_f32 v[184:185], v[184:185], v[232:233]
    v_pk_add_f32 v[186:187], v[186:187], v[234:235]
    v_pk_add_f32 v[188:189], v[188:189], v[236:237]
    v_pk_add_f32 v[190:191], v[190:191], v[238:239]
    v_pk_mul_f32 v[184:185], v[184:185], v[102:103] op_sel:[0,1] op_sel_hi:[1,1]
    v_pk_mul_f32 v[186:187], v[186:187], v[102:103] op_sel:[0,1] op_sel_hi:[1,1]
    v_pk_mul_f32 v[188:189], v[188:189], v[102:103] op_sel:[0,1] op_sel_hi:[1,1]
    v_pk_mul_f32 v[190:191], v[190:191], v[102:103] op_sel:[0,1] op_sel_hi:[1,1]
    v_cvt_pk_bf16_f32 v184, v184, v185
    v_cvt_pk_bf16_f32 v185, v186, v187
    v_cvt_pk_bf16_f32 v186, v188, v189
    v_cvt_pk_bf16_f32 v187, v190, v191
    buffer_store_dwordx4 v[184:187], v242, s[24:27], s47 offen offset:128 sc1 nt
    s_waitcnt lgkmcnt(0)
    v_add_f32 v24, v24, v25
    v_add_f32 v26, v26, v27
    s_lshr_b32 s51, s44, 1
    s_and_b32 s51, s51, s44
    v_add_f32 v24, v24, v26
    s_or_b32 s50, s95, s51
    s_cbranch_scc1 L_nx
    v_rcp_f32 v26, v24
    s_lshl_b32 s50, s44, 6
    s_add_u32 s50, s50, s3
    v_pk_add_f32 v[32:33], v[32:33], v[40:41]
    v_pk_add_f32 v[34:35], v[34:35], v[42:43]
    v_pk_add_f32 v[36:37], v[36:37], v[44:45]
    v_pk_add_f32 v[38:39], v[38:39], v[46:47]
    v_pk_add_f32 v[48:49], v[48:49], v[56:57]
    v_pk_add_f32 v[50:51], v[50:51], v[58:59]
    v_pk_add_f32 v[52:53], v[52:53], v[60:61]
    v_pk_add_f32 v[54:55], v[54:55], v[62:63]
    v_pk_add_f32 v[32:33], v[32:33], v[48:49]
    v_pk_add_f32 v[34:35], v[34:35], v[50:51]
    v_pk_add_f32 v[36:37], v[36:37], v[52:53]
    v_pk_add_f32 v[38:39], v[38:39], v[54:55]
    v_pk_mul_f32 v[32:33], v[32:33], v[26:27] op_sel_hi:[1,0]
    v_pk_mul_f32 v[34:35], v[34:35], v[26:27] op_sel_hi:[1,0]
    v_pk_mul_f32 v[36:37], v[36:37], v[26:27] op_sel_hi:[1,0]
    v_pk_mul_f32 v[38:39], v[38:39], v[26:27] op_sel_hi:[1,0]
    v_cvt_pk_bf16_f32 v8, v32, v33
    v_cvt_pk_bf16_f32 v9, v34, v35
    v_cvt_pk_bf16_f32 v10, v36, v37
    v_cvt_pk_bf16_f32 v11, v38, v39
    buffer_store_dwordx4 v[8:11], v243, s[24:27], s50 offen sc1 nt
L_nx:
    s_cmp_lg_u32 s62, 0
    s_cbranch_scc1 L_done
    s_cmp_lg_u32 s95, 0
    s_cselect_b64 vcc, -1, 0
    v_mov_b32 v20, 117504
    v_mov_b32 v21, 1
    v_cndmask_b32 v24, v24, 1.0, vcc
    v_cmp_nle_f32 vcc, s48, v94
    s_or_b64 s[64:65], s[64:65], vcc
    v_cmp_nge_f32 vcc, s49, v94
    s_or_b64 s[64:65], s[64:65], vcc
    v_cmp_nle_f32 vcc, s48, v98
    s_or_b64 s[64:65], s[64:65], vcc
    v_cmp_nge_f32 vcc, s49, v98
    s_or_b64 s[64:65], s[64:65], vcc
    v_cmp_nle_f32 vcc, s48, v102
    s_or_b64 s[64:65], s[64:65], vcc
    v_cmp_nge_f32 vcc, s49, v102
    s_or_b64 s[64:65], s[64:65], vcc
    v_cmp_nle_f32 vcc, s48, v24
    s_or_b64 s[64:65], s[64:65], vcc
    v_cmp_nge_f32 vcc, s49, v24
    s_or_b64 s[64:65], s[64:65], vcc
    v_cmp_lt_u32 vcc, 1, v89
    s_or_b64 s[64:65], s[64:65], vcc
    s_cmp_eq_u64 s[64:65], 0
    s_cbranch_scc1 L_ok
    ds_write_b32 v20, v21
L_ok:
    s_waitcnt lgkmcnt(0)
    s_barrier
    ds_read_b32 v21, v20
    s_waitcnt lgkmcnt(0)
    v_readfirstlane_b32 s48, v21
    s_nop 3
    s_cmp_eq_u32 s48, 0
    s_cbranch_scc1 L_done
    s_waitcnt vmcnt(0)
    v_mov_b32 v92, 0xff800000
    v_mov_b32 v96, 0xff800000
    v_mov_b32 v100, 0xff800000
    v_mov_b32 v104, 0xff800000
    v_mov_b32 v108, 0xff800000
    v_mov_b32 v112, 0xff800000
    v_mov_b32 v116, 0xff800000
    s_mov_b32 s60, s63
    s_mov_b32 s61, 16
L_fb:
    buffer_load_dwordx4 a[180:183], v3, s[28:31], s60 offen offset:0
    buffer_load_dwordx4 a[184:187], v3, s[28:31], s60 offen offset:1024
    buffer_load_dwordx4 a[188:191], v3, s[28:31], s60 offen offset:2048
    buffer_load_dwordx4 a[192:195], v3, s[28:31], s60 offen offset:3072
    buffer_load_dwordx4 a[196:199], v4, s[28:31], s60 offen offset:0
    buffer_load_dwordx4 a[200:203], v4, s[28:31], s60 offen offset:1024
    s_waitcnt vmcnt(0)
    v_mfma_f32_16x16x32_bf16 v[8:11], a[180:183], a[96:99], 0
    v_mfma_f32_16x16x32_bf16 v[8:11], a[184:187], a[100:103], v[8:11]
    v_mfma_f32_16x16x32_bf16 v[8:11], a[188:191], a[104:107], v[8:11]
    v_mfma_f32_16x16x32_bf16 v[12:15], a[192:195], a[96:99], 0
    v_mfma_f32_16x16x32_bf16 v[12:15], a[196:199], a[100:103], v[12:15]
    v_mfma_f32_16x16x32_bf16 v[12:15], a[200:203], a[104:107], v[12:15]
    s_nop 7
    v_max3_f32 v92, v8, v9, v92
    v_max3_f32 v92, v10, v11, v92
    v_max3_f32 v92, v12, v13, v92
    v_max3_f32 v92, v14, v15, v92
    v_mfma_f32_16x16x32_bf16 v[8:11], a[180:183], a[108:111], 0
    v_mfma_f32_16x16x32_bf16 v[8:11], a[184:187], a[112:115], v[8:11]
    v_mfma_f32_16x16x32_bf16 v[8:11], a[188:191], a[116:119], v[8:11]
    v_mfma_f32_16x16x32_bf16 v[12:15], a[192:195], a[108:111], 0
    v_mfma_f32_16x16x32_bf16 v[12:15], a[196:199], a[112:115], v[12:15]
    v_mfma_f32_16x16x32_bf16 v[12:15], a[200:203], a[116:119], v[12:15]
    s_nop 7
    v_max3_f32 v96, v8, v9, v96
    v_max3_f32 v96, v10, v11, v96
    v_max3_f32 v96, v12, v13, v96
    v_max3_f32 v96, v14, v15, v96
    v_mfma_f32_16x16x32_bf16 v[8:11], a[180:183], a[120:123], 0
    v_mfma_f32_16x16x32_bf16 v[8:11], a[184:187], a[124:127], v[8:11]
    v_mfma_f32_16x16x32_bf16 v[8:11], a[188:191], a[128:131], v[8:11]
    v_mfma_f32_16x16x32_bf16 v[12:15], a[192:195], a[120:123], 0
    v_mfma_f32_16x16x32_bf16 v[12:15], a[196:199], a[124:127], v[12:15]
    v_mfma_f32_16x16x32_bf16 v[12:15], a[200:203], a[128:131], v[12:15]
    s_nop 7
    v_max3_f32 v100, v8, v9, v100
    v_max3_f32 v100, v10, v11, v100
    v_max3_f32 v100, v12, v13, v100
    v_max3_f32 v100, v14, v15, v100
    v_mfma_f32_16x16x32_bf16 v[8:11], a[180:183], a[132:135], 0
    v_mfma_f32_16x16x32_bf16 v[8:11], a[184:187], a[136:139], v[8:11]
    v_mfma_f32_16x16x32_bf16 v[8:11], a[188:191], a[140:143], v[8:11]
    v_mfma_f32_16x16x32_bf16 v[12:15], a[192:195], a[132:135], 0
    v_mfma_f32_16x16x32_bf16 v[12:15], a[196:199], a[136:139], v[12:15]
    v_mfma_f32_16x16x32_bf16 v[12:15], a[200:203], a[140:143], v[12:15]
    s_nop 7
    v_max3_f32 v104, v8, v9, v104
    v_max3_f32 v104, v10, v11, v104
    v_max3_f32 v104, v12, v13, v104
    v_max3_f32 v104, v14, v15, v104
    v_mfma_f32_16x16x32_bf16 v[8:11], a[180:183], a[144:147], 0
    v_mfma_f32_16x16x32_bf16 v[8:11], a[184:187], a[148:151], v[8:11]
    v_mfma_f32_16x16x32_bf16 v[8:11], a[188:191], a[152:155], v[8:11]
    v_mfma_f32_16x16x32_bf16 v[12:15], a[192:195], a[144:147], 0
    v_mfma_f32_16x16x32_bf16 v[12:15], a[196:199], a[148:151], v[12:15]
    v_mfma_f32_16x16x32_bf16 v[12:15], a[200:203], a[152:155], v[12:15]
    s_nop 7
    v_max3_f32 v108, v8, v9, v108
    v_max3_f32 v108, v10, v11, v108
    v_max3_f32 v108, v12, v13, v108
    v_max3_f32 v108, v14, v15, v108
    v_mfma_f32_16x16x32_bf16 v[8:11], a[180:183], a[156:159], 0
    v_mfma_f32_16x16x32_bf16 v[8:11], a[184:187], a[160:163], v[8:11]
    v_mfma_f32_16x16x32_bf16 v[8:11], a[188:191], a[164:167], v[8:11]
    v_mfma_f32_16x16x32_bf16 v[12:15], a[192:195], a[156:159], 0
    v_mfma_f32_16x16x32_bf16 v[12:15], a[196:199], a[160:163], v[12:15]
    v_mfma_f32_16x16x32_bf16 v[12:15], a[200:203], a[164:167], v[12:15]
    s_nop 7
    v_max3_f32 v112, v8, v9, v112
    v_max3_f32 v112, v10, v11, v112
    v_max3_f32 v112, v12, v13, v112
    v_max3_f32 v112, v14, v15, v112
    v_mfma_f32_16x16x32_bf16 v[8:11], a[180:183], a[168:171], 0
    v_mfma_f32_16x16x32_bf16 v[8:11], a[184:187], a[172:175], v[8:11]
    v_mfma_f32_16x16x32_bf16 v[8:11], a[188:191], a[176:179], v[8:11]
    v_mfma_f32_16x16x32_bf16 v[12:15], a[192:195], a[168:171], 0
    v_mfma_f32_16x16x32_bf16 v[12:15], a[196:199], a[172:175], v[12:15]
    v_mfma_f32_16x16x32_bf16 v[12:15], a[200:203], a[176:179], v[12:15]
    s_nop 7
    v_max3_f32 v116, v8, v9, v116
    v_max3_f32 v116, v10, v11, v116
    v_max3_f32 v116, v12, v13, v116
    v_max3_f32 v116, v14, v15, v116
    s_bitcmp1_b32 s61, 0
    s_cselect_b32 s48, 24576, 0
    s_add_u32 s60, s60, s48
    s_add_u32 s60, s60, 12288
    s_sub_u32 s61, s61, 1
    s_cmp_lg_u32 s61, 0
    s_cbranch_scc1 L_fb
    ds_write_b32 v6, v92 offset:0
    ds_write_b32 v6, v96 offset:1024
    ds_write_b32 v6, v100 offset:2048
    ds_write_b32 v6, v104 offset:3072
    ds_write_b32 v6, v108 offset:4096
    ds_write_b32 v6, v112 offset:5120
    ds_write_b32 v6, v116 offset:6144
    v_and_b32 v8, 0x300, v3
    v_sub_u32 v9, v6, v8
    v_sub_u32 v10, v7, v8
    s_waitcnt lgkmcnt(0)
    s_barrier
    ds_read_b32 v12, v9 offset:0
    ds_read_b32 v16, v10 offset:3072
    ds_read_b32 v13, v9 offset:256
    ds_read_b32 v17, v10 offset:3328
    ds_read_b32 v14, v9 offset:512
    ds_read_b32 v18, v10 offset:3584
    ds_read_b32 v15, v9 offset:768
    ds_read_b32 v19, v10 offset:3840
    s_waitcnt lgkmcnt(0)
    v_max3_f32 v12, v12, v13, v14
    v_max3_f32 v12, v12, v15, v16
    v_max3_f32 v12, v12, v17, v18
    v_max_f32 v12, v12, v19
    v_sub_f32 v92, 0, v12
    v_sub_f32 v93, 0, v12
    v_sub_f32 v94, 0, v12
    v_sub_f32 v95, 0, v12
    ds_read_b32 v12, v9 offset:1024
    ds_read_b32 v16, v10 offset:4096
    ds_read_b32 v13, v9 offset:1280
    ds_read_b32 v17, v10 offset:4352
    ds_read_b32 v14, v9 offset:1536
    ds_read_b32 v18, v10 offset:4608
    ds_read_b32 v15, v9 offset:1792
    ds_read_b32 v19, v10 offset:4864
    s_waitcnt lgkmcnt(0)
    v_max3_f32 v12, v12, v13, v14
    v_max3_f32 v12, v12, v15, v16
    v_max3_f32 v12, v12, v17, v18
    v_max_f32 v12, v12, v19
    v_sub_f32 v96, 0, v12
    v_sub_f32 v97, 0, v12
    v_sub_f32 v98, 0, v12
    v_sub_f32 v99, 0, v12
    ds_read_b32 v12, v9 offset:2048
    ds_read_b32 v16, v10 offset:5120
    ds_read_b32 v13, v9 offset:2304
    ds_read_b32 v17, v10 offset:5376
    ds_read_b32 v14, v9 offset:2560
    ds_read_b32 v18, v10 offset:5632
    ds_read_b32 v15, v9 offset:2816
    ds_read_b32 v19, v10 offset:5888
    s_waitcnt lgkmcnt(0)
    v_max3_f32 v12, v12, v13, v14
    v_max3_f32 v12, v12, v15, v16
    v_max3_f32 v12, v12, v17, v18
    v_max_f32 v12, v12, v19
    v_sub_f32 v100, 0, v12
    v_sub_f32 v101, 0, v12
    v_sub_f32 v102, 0, v12
    v_sub_f32 v103, 0, v12
    ds_read_b32 v12, v9 offset:3072
    ds_read_b32 v16, v10 offset:0
    ds_read_b32 v13, v9 offset:3328
    ds_read_b32 v17, v10 offset:256
    ds_read_b32 v14, v9 offset:3584
    ds_read_b32 v18, v10 offset:512
    ds_read_b32 v15, v9 offset:3840
    ds_read_b32 v19, v10 offset:768
    s_waitcnt lgkmcnt(0)
    v_max3_f32 v12, v12, v13, v14
    v_max3_f32 v12, v12, v15, v16
    v_max3_f32 v12, v12, v17, v18
    v_max_f32 v12, v12, v19
    v_sub_f32 v104, 0, v12
    v_sub_f32 v105, 0, v12
    v_sub_f32 v106, 0, v12
    v_sub_f32 v107, 0, v12
    ds_read_b32 v12, v9 offset:4096
    ds_read_b32 v16, v10 offset:1024
    ds_read_b32 v13, v9 offset:4352
    ds_read_b32 v17, v10 offset:1280
    ds_read_b32 v14, v9 offset:4608
    ds_read_b32 v18, v10 offset:1536
    ds_read_b32 v15, v9 offset:4864
    ds_read_b32 v19, v10 offset:1792
    s_waitcnt lgkmcnt(0)
    v_max3_f32 v12, v12, v13, v14
    v_max3_f32 v12, v12, v15, v16
    v_max3_f32 v12, v12, v17, v18
    v_max_f32 v12, v12, v19
    v_sub_f32 v108, 0, v12
    v_sub_f32 v109, 0, v12
    v_sub_f32 v110, 0, v12
    v_sub_f32 v111, 0, v12
    ds_read_b32 v12, v9 offset:5120
    ds_read_b32 v16, v10 offset:2048
    ds_read_b32 v13, v9 offset:5376
    ds_read_b32 v17, v10 offset:2304
    ds_read_b32 v14, v9 offset:5632
    ds_read_b32 v18, v10 offset:2560
    ds_read_b32 v15, v9 offset:5888
    ds_read_b32 v19, v10 offset:2816
    s_waitcnt lgkmcnt(0)
    v_max3_f32 v12, v12, v13, v14
    v_max3_f32 v12, v12, v15, v16
    v_max3_f32 v12, v12, v17, v18
    v_max_f32 v12, v12, v19
    v_sub_f32 v112, 0, v12
    v_sub_f32 v113, 0, v12
    v_sub_f32 v114, 0, v12
    v_sub_f32 v115, 0, v12
    ds_read_b32 v12, v9 offset:6144
    ds_read_b32 v16, v10 offset:6144
    ds_read_b32 v13, v9 offset:6400
    ds_read_b32 v17, v10 offset:6400
    ds_read_b32 v14, v9 offset:6656
    ds_read_b32 v18, v10 offset:6656
    ds_read_b32 v15, v9 offset:6912
    ds_read_b32 v19, v10 offset:6912
    s_waitcnt lgkmcnt(0)
    v_max3_f32 v12, v12, v13, v14
    v_max3_f32 v12, v12, v15, v16
    v_max3_f32 v12, v12, v17, v18
    v_max_f32 v12, v12, v19
    v_sub_f32 v116, 0, v12
    v_sub_f32 v117, 0, v12
    v_sub_f32 v118, 0, v12
    v_sub_f32 v119, 0, v12
    v_accvgpr_write_b32 a0, 0
    v_accvgpr_write_b32 a1, 0
    v_accvgpr_write_b32 a2, 0
    v_accvgpr_write_b32 a3, 0
    v_accvgpr_write_b32 a4, 0
    v_accvgpr_write_b32 a5, 0
    v_accvgpr_write_b32 a6, 0
    v_accvgpr_write_b32 a7, 0
    v_accvgpr_write_b32 a8, 0
    v_accvgpr_write_b32 a9, 0
    v_accvgpr_write_b32 a10, 0
    v_accvgpr_write_b32 a11, 0
    v_accvgpr_write_b32 a12, 0
    v_accvgpr_write_b32 a13, 0
    v_accvgpr_write_b32 a14, 0
    v_accvgpr_write_b32 a15, 0
    v_accvgpr_write_b32 a16, 0
    v_accvgpr_write_b32 a17, 0
    v_accvgpr_write_b32 a18, 0
    v_accvgpr_write_b32 a19, 0
    v_accvgpr_write_b32 a20, 0
    v_accvgpr_write_b32 a21, 0
    v_accvgpr_write_b32 a22, 0
    v_accvgpr_write_b32 a23, 0
    v_accvgpr_write_b32 a24, 0
    v_accvgpr_write_b32 a25, 0
    v_accvgpr_write_b32 a26, 0
    v_accvgpr_write_b32 a27, 0
    v_accvgpr_write_b32 a28, 0
    v_accvgpr_write_b32 a29, 0
    v_accvgpr_write_b32 a30, 0
    v_accvgpr_write_b32 a31, 0
    v_accvgpr_write_b32 a32, 0
    v_accvgpr_write_b32 a33, 0
    v_accvgpr_write_b32 a34, 0
    v_accvgpr_write_b32 a35, 0
    v_accvgpr_write_b32 a36, 0
    v_accvgpr_write_b32 a37, 0
    v_accvgpr_write_b32 a38, 0
    v_accvgpr_write_b32 a39, 0
    v_accvgpr_write_b32 a40, 0
    v_accvgpr_write_b32 a41, 0
    v_accvgpr_write_b32 a42, 0
    v_accvgpr_write_b32 a43, 0
    v_accvgpr_write_b32 a44, 0
    v_accvgpr_write_b32 a45, 0
    v_accvgpr_write_b32 a46, 0
    v_accvgpr_write_b32 a47, 0
    v_accvgpr_write_b32 a48, 0
    v_accvgpr_write_b32 a49, 0
    v_accvgpr_write_b32 a50, 0
    v_accvgpr_write_b32 a51, 0
    v_accvgpr_write_b32 a52, 0
    v_accvgpr_write_b32 a53, 0
    v_accvgpr_write_b32 a54, 0
    v_accvgpr_write_b32 a55, 0
    v_accvgpr_write_b32 a56, 0
    v_accvgpr_write_b32 a57, 0
    v_accvgpr_write_b32 a58, 0
    v_accvgpr_write_b32 a59, 0
    v_accvgpr_write_b32 a60, 0
    v_accvgpr_write_b32 a61, 0
    v_accvgpr_write_b32 a62, 0
    v_accvgpr_write_b32 a63, 0
    v_accvgpr_write_b32 a64, 0
    v_accvgpr_write_b32 a65, 0
    v_accvgpr_write_b32 a66, 0
    v_accvgpr_write_b32 a67, 0
    v_accvgpr_write_b32 a68, 0
    v_accvgpr_write_b32 a69, 0
    v_accvgpr_write_b32 a70, 0
    v_accvgpr_write_b32 a71, 0
    v_accvgpr_write_b32 a72, 0
    v_accvgpr_write_b32 a73, 0
    v_accvgpr_write_b32 a74, 0
    v_accvgpr_write_b32 a75, 0
    v_accvgpr_write_b32 a76, 0
    v_accvgpr_write_b32 a77, 0
    v_accvgpr_write_b32 a78, 0
    v_accvgpr_write_b32 a79, 0
    v_accvgpr_write_b32 a80, 0
    v_accvgpr_write_b32 a81, 0
    v_accvgpr_write_b32 a82, 0
    v_accvgpr_write_b32 a83, 0
    v_accvgpr_write_b32 a84, 0
    v_accvgpr_write_b32 a85, 0
    v_accvgpr_write_b32 a86, 0
    v_accvgpr_write_b32 a87, 0
    v_accvgpr_write_b32 a88, 0
    v_accvgpr_write_b32 a89, 0
    v_accvgpr_write_b32 a90, 0
    v_accvgpr_write_b32 a91, 0
    v_accvgpr_write_b32 a92, 0
    v_accvgpr_write_b32 a93, 0
    v_accvgpr_write_b32 a94, 0
    v_accvgpr_write_b32 a95, 0
    v_accvgpr_write_b32 a228, 0
    v_accvgpr_write_b32 a229, 0
    v_accvgpr_write_b32 a230, 0
    v_accvgpr_write_b32 a231, 0
    v_accvgpr_write_b32 a232, 0
    v_accvgpr_write_b32 a233, 0
    v_accvgpr_write_b32 a234, 0
    v_accvgpr_write_b32 a235, 0
    v_accvgpr_write_b32 a236, 0
    v_accvgpr_write_b32 a237, 0
    v_accvgpr_write_b32 a238, 0
    v_accvgpr_write_b32 a239, 0
    v_accvgpr_write_b32 a240, 0
    v_accvgpr_write_b32 a241, 0
    v_accvgpr_write_b32 a242, 0
    v_accvgpr_write_b32 a243, 0
    v_accvgpr_write_b32 a244, 0
    v_accvgpr_write_b32 a245, 0
    v_accvgpr_write_b32 a246, 0
    v_accvgpr_write_b32 a247, 0
    v_accvgpr_write_b32 a248, 0
    v_accvgpr_write_b32 a249, 0
    v_accvgpr_write_b32 a250, 0
    v_accvgpr_write_b32 a251, 0
    v_accvgpr_write_b32 a252, 0
    v_accvgpr_write_b32 a253, 0
    v_accvgpr_write_b32 a254, 0
    v_accvgpr_write_b32 a255, 0
    v_mov_b32 v120, 0
    v_mov_b32 v121, 0
    v_mov_b32 v122, 0
    v_mov_b32 v123, 0
    v_mov_b32 v124, 0
    v_mov_b32 v125, 0
    v_mov_b32 v126, 0
    v_mov_b32 v127, 0
    v_mov_b32 v128, 0
    v_mov_b32 v129, 0
    v_mov_b32 v130, 0
    v_mov_b32 v131, 0
    v_mov_b32 v132, 0
    v_mov_b32 v133, 0
    v_mov_b32 v134, 0
    v_mov_b32 v135, 0
    v_mov_b32 v136, 0
    v_mov_b32 v137, 0
    v_mov_b32 v138, 0
    v_mov_b32 v139, 0
    v_mov_b32 v140, 0
    v_mov_b32 v141, 0
    v_mov_b32 v142, 0
    v_mov_b32 v143, 0
    v_mov_b32 v144, 0
    v_mov_b32 v145, 0
    v_mov_b32 v146, 0
    v_mov_b32 v147, 0
    v_mov_b32 v148, 0
    v_mov_b32 v149, 0
    v_mov_b32 v150, 0
    v_mov_b32 v151, 0
    v_mov_b32 v152, 0
    v_mov_b32 v153, 0
    v_mov_b32 v154, 0
    v_mov_b32 v155, 0
    v_mov_b32 v156, 0
    v_mov_b32 v157, 0
    v_mov_b32 v158, 0
    v_mov_b32 v159, 0
    v_mov_b32 v160, 0
    v_mov_b32 v161, 0
    v_mov_b32 v162, 0
    v_mov_b32 v163, 0
    v_mov_b32 v164, 0
    v_mov_b32 v165, 0
    v_mov_b32 v166, 0
    v_mov_b32 v167, 0
    v_mov_b32 v168, 0
    v_mov_b32 v169, 0
    v_mov_b32 v170, 0
    v_mov_b32 v171, 0
    v_mov_b32 v172, 0
    v_mov_b32 v173, 0
    v_mov_b32 v174, 0
    v_mov_b32 v175, 0
    v_mov_b32 v176, 0
    v_mov_b32 v177, 0
    v_mov_b32 v178, 0
    v_mov_b32 v179, 0
    v_mov_b32 v180, 0
    v_mov_b32 v181, 0
    v_mov_b32 v182, 0
    v_mov_b32 v183, 0
    v_mov_b32 v184, 0
    v_mov_b32 v185, 0
    v_mov_b32 v186, 0
    v_mov_b32 v187, 0
    v_mov_b32 v188, 0
    v_mov_b32 v189, 0
    v_mov_b32 v190, 0
    v_mov_b32 v191, 0
    s_barrier
    s_mov_b32 s62, 1
    s_branch L_pass
L_slow0:
    s_mov_b32 s49, 0x200000
L_slowp0:
    buffer_load_dword v89, v90, s[28:31], 0 offen sc1
    s_sub_u32 s49, s49, 1
    s_cbranch_scc1 L_back0
    s_waitcnt vmcnt(0)
    v_cmp_eq_u32 vcc, 0, v89
    s_nop 1
    s_cbranch_vccnz L_slowp0
    s_branch L_back0
L_slow1:
    s_mov_b32 s49, 0x200000
L_slowp1:
    buffer_load_dword v89, v90, s[28:31], 0 offen sc1
    s_sub_u32 s49, s49, 1
    s_cbranch_scc1 L_back1
    s_waitcnt vmcnt(0)
    v_cmp_eq_u32 vcc, 0, v89
    s_nop 1
    s_cbranch_vccnz L_slowp1
    s_branch L_back1
L_slowNone:
    s_mov_b32 s49, 0x200000
L_slowpNone:
    buffer_load_dword v89, v90, s[28:31], 0 offen sc1
    s_sub_u32 s49, s49, 1
    s_cbranch_scc1 L_backNone
    s_waitcnt vmcnt(0)
    v_cmp_eq_u32 vcc, 0, v89
    s_nop 1
    s_cbranch_vccnz L_slowpNone
    s_branch L_backNone
L_done:
    s_endpgm
L_end:
.section .rodata,"a"
.p2align 6
.amdhsa_kernel standalone__window_attn_twins__vision_kernel
  .amdhsa_next_free_vgpr 512
  .amdhsa_next_free_sgpr 100
  .amdhsa_accum_offset 256
  .amdhsa_group_segment_fixed_size 0
  .amdhsa_kernarg_size 56
  .amdhsa_user_sgpr_count 2
  .amdhsa_user_sgpr_kernarg_segment_ptr 1
  .amdhsa_system_sgpr_workgroup_id_x 1
.end_amdhsa_kernel
```
